```python
import torch

def _softmax(x, axis=-1):
    return torch.softmax(x, dim=axis)
def _gelu(x):
    return torch.nn.functional.gelu(x, approximate="tanh")
def _silu(x):
    return torch.nn.functional.silu(x)
def _sigmoid(x):
    return torch.sigmoid(x)
def _layernorm(x, axis=-1, eps=1e-5):
    m = x.mean(dim=axis, keepdim=True)
    v = x.var(dim=axis, keepdim=True, unbiased=False)
    return (x - m) / torch.sqrt(v + eps)
def _scatter_add(tgt, idx, src, axis=0):
    return tgt.clone().index_add_(axis, idx, src)
def _segment_sum(src, seg, n):
    out = torch.zeros((n,) + src.shape[1:], dtype=src.dtype)
    return out.index_add_(0, seg, src)
def _pad(x, pw):
    flat = tuple(v for pair in reversed(pw) for v in pair)
    return torch.nn.functional.pad(x, flat)

kernel_name = 'standalone__ragged_sequences_packed_sequences__ragged'

def setup_inputs():

    _w = (lambda a: (lambda t: t.to(torch.bfloat16) if t.is_floating_point() else t)(torch.as_tensor(a)))
    cu = torch.tensor([0, 369, 582, 865, 1200], dtype=torch.int64)
    T = int(cu[-1])
    H, D = 16, 128
    lens = torch.diff(cu)
    seg_ids = torch.repeat_interleave(torch.arange(len(lens), dtype=torch.int64), lens)
    return {
        "q": _w((lambda *s: torch.randn(*s, dtype=torch.bfloat16) * 0.8)(T, H, D)),
        "k": _w((lambda *s: torch.randn(*s, dtype=torch.bfloat16) * 0.8)(T, H, D)),
        "v": _w((lambda *s: torch.randn(*s, dtype=torch.bfloat16) * 0.05)(T, H, D)),
        "seg_ids": _w(seg_ids),
    }

def reference(q, k, v, seg_ids):
    T, H, D = q.shape
    scale = D ** -0.5
    same_seq = seg_ids[:, None] == seg_ids[None, :]
    logits = torch.einsum("qhd,khd->hqk", q, k) * scale
    bias = (1.0 - (lambda x, dt: x.to(dt))(same_seq, q.dtype)) * (-1e9)
    p = _softmax(logits + bias[None, :, :], axis=-1)
    return torch.einsum("hqk,khd->qhd", p, v)
```

```asm
; @launch grid=(256,1,1) block=(512,1,1) lds=163840
.amdgcn_target "amdgcn-amd-amdhsa--gfx950"
.text
.globl standalone__ragged_sequences_packed_sequences__ragged_kernel
.p2align 12
.p2align 8
.type standalone__ragged_sequences_packed_sequences__ragged_kernel,@function
standalone__ragged_sequences_packed_sequences__ragged_kernel:
    s_cmpk_ge_u32 s2, 0x100
    s_cbranch_scc1 L_end
    s_load_dwordx4 s[4:7], s[0:1], 0
    s_load_dwordx2 s[8:9], s[0:1], 16
    s_getpc_b64 s[12:13]
L_pc0:
    v_lshrrev_b32 v1, 6, v0
    s_bfe_u32 s3, s2, 0x40003
    v_readfirstlane_b32 s14, v1
    s_and_b32 s15, s2, 7
    s_lshr_b32 s16, s2, 7
    s_lshl3_add_u32 s15, s16, s15
    s_lshl_b32 s15, s15, 2
    s_mov_b32 s16, 0xeb863091
    s_mov_b32 s17, 0xfca742d5
    s_lshr_b64 s[16:17], s[16:17], s15
    s_and_b32 s15, s16, 15
    s_lshl_b32 s15, s15, 8
    s_cmp_ge_u32 s14, 4
    s_cbranch_scc0 L_loader
    s_cmp_eq_u32 s3, 7
    s_cbranch_scc0 L_compute
    v_and_b32 v1, 0xff, v0
    v_lshlrev_b32 v1, 6, v1
    v_min_u32 v1, L_tabend-L_pc0-4, v1
    global_load_dword v240, v1, s[12:13]
    s_branch L_compute
L_loader:
    s_setprio 3
    v_bfe_u32 v1, v0, 4, 2
    v_and_b32 v2, 15, v0
    v_lshlrev_b32 v3, 14, v1
    v_lshl_add_u32 v3, v2, 4, v3
    v_lshl_add_u32 v3, s14, 12, v3
    v_and_b32 v1, 32, v0
    v_lshlrev_b32 v1, 2, v1
    v_xor_b32 v1, v1, v3
    v_add_u32 v2, 0x10000, v1
    s_mul_i32 s80, s14, 1040
    s_cmp_ge_u32 s3, 6
    s_cselect_b32 s82, 1511424, 0
    s_cmp_ge_u32 s3, 8
    s_cselect_b32 s82, 2383872, s82
    s_cmp_ge_u32 s3, 11
    s_cselect_b32 s82, 3543040, s82
    s_lshl_b32 s16, s3, 2
    s_mov_b32 s84, 0x40a86420
    s_mov_b32 s85, 0x86420630
    s_lshr_b64 s[84:85], s[84:85], s16
    s_and_b32 s84, s84, 15
    s_mov_b32 s86, 0x23555555
    s_mov_b32 s87, 0x25555aaa
    s_lshr_b64 s[86:87], s[86:87], s16
    s_bfe_u32 s87, s86, 0x20002
    s_mul_i32 s87, s87, 17024
    s_add_u32 s87, s87, s80
    s_and_b32 s86, s86, 3
    s_mov_b32 s88, 0x303030
    s_mov_b32 s89, 0x3030000
    s_lshr_b64 s[88:89], s[88:89], s16
    s_and_b32 s88, s88, 15
    s_mul_i32 s85, s86, 4294958976
    s_add_u32 s85, s85, s80
    s_lshl_b32 s84, s84, 17
    s_lshl_b32 s88, s88, 17
    s_add_u32 s84, s84, s82
    s_add_u32 s88, s88, s82
    s_mov_b32 s50, 4911360
    s_cmp_lt_u32 s3, 6
    s_cselect_b32 s54, 1507584, s50
    s_mul_i32 s3, s3, 384
    s_add_u32 s3, s3, L_table-L_pc0
    s_add_u32 s90, s12, s3
    s_addc_u32 s91, s13, 0
    s_mov_b32 s51, 0x20000
    s_mov_b32 s55, s51
    s_mov_b32 m0, s87
    s_waitcnt lgkmcnt(0)
    s_load_dwordx16 s[16:31], s[90:91], 0
    s_load_dwordx16 s[32:47], s[90:91], 64
    s_add_u32 s52, s6, s15
    s_addc_u32 s53, s7, 0
    s_add_u32 s48, s4, s15
    s_addc_u32 s49, s5, 0
    buffer_load_dwordx4 v1, s[52:55], s88 offen lds
    s_addk_i32 m0, 4160
    s_cmp_eq_u32 s86, 1
    buffer_load_dwordx4 v2, s[52:55], s88 offen lds
    s_cbranch_scc1 L_searly
L_sback:
    s_add_u32 m0, s85, 152832
L_ldq:
    buffer_load_dwordx4 v1, s[48:51], s84 offen lds
    s_addk_i32 m0, 4160
    s_nop 0
    buffer_load_dwordx4 v2, s[48:51], s84 offen lds
    s_addk_i32 m0, 4160
    s_add_u32 s84, s84, s51
    s_sub_u32 s86, s86, 1
    s_cbranch_scc0 L_ldq
L_ldtab:
    s_setprio 0
    v_add_u32 v4, 0x10000, v3
    s_mul_i32 s81, s14, 1088
    s_addk_i32 s81, 8320
    s_mov_b32 s59, s51
    s_mov_b32 s83, 0
    s_waitcnt lgkmcnt(0)
    s_xor_b32 s82, s17, 1
    s_lshl_b32 s82, s82, 7
    s_add_u32 s46, s46, s15
    s_add_u32 s52, s6, s46
    s_addc_u32 s53, s7, 0
    s_mov_b32 s54, s47
    s_add_u32 s56, s8, s46
    s_addc_u32 s57, s9, 0
    s_mov_b32 s58, s47
L_unit:
    s_mov_b32 m0, s83
    s_add_u32 s83, s83, 2
    s_movrels_b64 s[84:85], s[20:21]
    s_and_b32 s86, s84, 0x1ffff
    s_lshl1_add_u32 m0, s86, s81
    s_and_b32 s86, s84, 0x3e0000
    buffer_load_dwordx4 v3, s[56:59], s86 offen lds
    s_addk_i32 m0, 4352
    s_and_b32 s87, s85, 0x1ffff
    buffer_load_dwordx4 v4, s[56:59], s86 offen lds
    s_lshl1_add_u32 m0, s87, s80
    s_and_b32 s86, s85, 0x3e0000
    buffer_load_dwordx4 v1, s[52:55], s86 offen lds
    s_addk_i32 m0, 4160
    s_bitcmp1_b32 s85, 31
    buffer_load_dwordx4 v2, s[52:55], s86 offen lds
    v_xor_b32 v3, s82, v3
    v_xor_b32 v4, s82, v4
    s_cbranch_scc0 L_nobar
    s_waitcnt vmcnt(8)
    s_barrier
    s_bitcmp1_b32 s85, 30
    s_cbranch_scc0 L_nobar
    s_barrier
L_nobar:
    s_cmp_lt_u32 s83, s16
    s_cbranch_scc1 L_unit
    s_and_b32 s86, s18, 0x1ffff
    s_lshl1_add_u32 m0, s86, s81
    s_and_b32 s86, s18, 0x3e0000
    buffer_load_dwordx4 v3, s[56:59], s86 offen lds
    s_addk_i32 m0, 4352
    s_cmp_eq_u32 s17, 0
    buffer_load_dwordx4 v4, s[56:59], s86 offen lds
    v_xor_b32 v3, s82, v3
    v_xor_b32 v4, s82, v4
    s_and_b32 s86, s19, 0x1ffff
    s_lshl1_add_u32 m0, s86, s81
    s_and_b32 s86, s19, 0x3e0000
    buffer_load_dwordx4 v3, s[56:59], s86 offen lds
    s_addk_i32 m0, 4352
    s_cmp_eq_u32 s17, 0
    buffer_load_dwordx4 v4, s[56:59], s86 offen lds
    s_cbranch_scc1 L_ldt1
    s_waitcnt vmcnt(8)
    s_barrier
L_ldt1:
    s_waitcnt vmcnt(4)
    s_barrier
    s_waitcnt vmcnt(0)
    s_barrier
L_end:
    s_endpgm
L_searly:
    s_add_u32 m0, s87, 68096
    s_add_u32 s89, s88, 786432
    buffer_load_dwordx4 v1, s[52:55], s89 offen lds
    s_addk_i32 m0, 4160
    s_nop 0
    buffer_load_dwordx4 v2, s[52:55], s89 offen lds
    v_add_u32 v4, 0x10000, v3
    s_mul_i32 s81, s14, 1088
    s_addk_i32 s81, 8320
    s_add_u32 s56, s8, s15
    s_addc_u32 s57, s9, 0
    s_mov_b64 s[58:59], s[54:55]
    s_add_u32 m0, s81, 17024
    s_nop 0
    buffer_load_dwordx4 v3, s[56:59], s88 offen lds
    s_addk_i32 m0, 4352
    s_nop 0
    buffer_load_dwordx4 v4, s[56:59], s88 offen lds
    v_xor_b32 v3, 0x80, v3
    v_xor_b32 v4, 0x80, v4
    s_add_u32 m0, s81, 85120
    s_nop 0
    buffer_load_dwordx4 v3, s[56:59], s89 offen lds
    s_addk_i32 m0, 4352
    s_nop 0
    buffer_load_dwordx4 v4, s[56:59], s89 offen lds
    v_xor_b32 v3, 0x80, v3
    v_xor_b32 v4, 0x80, v4
    s_sub_u32 s83, s88, s82
    s_cmp_eq_u32 s83, 655360
    s_cselect_b32 s83, 4294311936, s51
    s_add_u32 m0, s80, 34048
    s_add_u32 s88, s88, s83
    buffer_load_dwordx4 v1, s[52:55], s88 offen lds
    s_addk_i32 m0, 4160
    s_nop 0
    buffer_load_dwordx4 v2, s[52:55], s88 offen lds
    s_add_u32 m0, s80, 102144
    s_add_u32 s89, s89, s83
    buffer_load_dwordx4 v1, s[52:55], s89 offen lds
    s_addk_i32 m0, 4160
    s_nop 0
    buffer_load_dwordx4 v2, s[52:55], s89 offen lds
    s_branch L_sback
L_compute:
    s_load_dwordx2 s[10:11], s[0:1], 32
    s_mul_i32 s82, s3, 6
    s_add_u32 s82, s82, s14
    s_lshl_b32 s82, s82, 6
    s_add_u32 s82, s82, L_table-L_pc0-128
    s_add_u32 s82, s12, s82
    s_addc_u32 s83, s13, 0
    s_load_dwordx16 s[16:31], s[82:83], 0
    v_and_b32 v0, 63, v0
    s_mov_b32 s51, 0x20000
    s_mov_b32 s55, s51
    s_mov_b32 s59, s51
    v_and_b32 v28, 3, v0
    v_mul_u32_u24 v1, 1040, v28
    v_bfe_u32 v28, v0, 4, 1
    v_mul_u32_u24 v29, 4160, v28
    v_add_u32 v1, v1, v29
    v_bfe_u32 v29, v0, 2, 2
    v_lshl_add_u32 v1, v29, 8, v1
    v_mul_u32_u24 v2, 1088, v29
    v_lshl_add_u32 v2, v28, 4, v2
    v_lshrrev_b32 v30, 5, v0
    v_lshl_add_u32 v2, v30, 8, v2
    v_bfe_u32 v31, v0, 3, 1
    v_xor_b32 v31, v31, v30
    v_lshl_add_u32 v1, v31, 7, v1
    v_and_b32 v31, 1, v0
    v_lshl_add_u32 v2, v31, 5, v2
    v_bfe_u32 v31, v0, 1, 1
    v_lshl_add_u32 v2, v31, 3, v2
    v_and_b32 v29, 1, v29
    v_cmp_eq_u32 vcc, v28, v29
    v_mov_b32 v29, 0x3f803f80
    v_lshlrev_b32 v5, 4, v0
    v_cndmask_b32 v16, 0, v29, vcc
    v_cndmask_b32 v17, 0, v29, vcc
    v_cndmask_b32 v18, 0, v29, vcc
    v_cndmask_b32 v19, 0, v29, vcc
    v_and_b32 v28, 7, v0
    v_lshlrev_b32 v29, 1, v30
    v_xor_b32 v29, v29, v28
    v_and_b32 v31, 31, v0
    v_lshlrev_b32 v31, 7, v31
    v_lshl_add_u32 v6, v29, 4, v31
    v_lshrrev_b32 v29, 3, v0
    v_xor_b32 v31, v29, v28
    v_lshlrev_b32 v31, 4, v31
    v_lshl_add_u32 v10, v29, 7, v31
    v_lshlrev_b32 v31, 4, v28
    v_lshl_add_u32 v11, v29, 12, v31
    s_mov_b32 s60, 0x3e0293ee
    s_mov_b32 s61, s60
    v_mov_b32 v64, 0
    v_mov_b32 v65, 0
    v_mov_b32 v66, 0
    v_mov_b32 v67, 0
    v_mov_b32 v68, 0
    v_mov_b32 v69, 0
    v_mov_b32 v70, 0
    v_mov_b32 v71, 0
    v_mov_b32 v72, 0
    v_mov_b32 v73, 0
    v_mov_b32 v74, 0
    v_mov_b32 v75, 0
    v_mov_b32 v76, 0
    v_mov_b32 v77, 0
    v_mov_b32 v78, 0
    v_mov_b32 v79, 0
    v_mov_b32 v80, 0
    v_mov_b32 v81, 0
    v_mov_b32 v82, 0
    v_mov_b32 v83, 0
    v_mov_b32 v84, 0
    v_mov_b32 v85, 0
    v_mov_b32 v86, 0
    v_mov_b32 v87, 0
    v_mov_b32 v88, 0
    v_mov_b32 v89, 0
    v_mov_b32 v90, 0
    v_mov_b32 v91, 0
    v_mov_b32 v92, 0
    v_mov_b32 v93, 0
    v_mov_b32 v94, 0
    v_mov_b32 v95, 0
    v_mov_b32 v96, 0
    v_mov_b32 v97, 0
    v_mov_b32 v98, 0
    v_mov_b32 v99, 0
    v_mov_b32 v100, 0
    v_mov_b32 v101, 0
    v_mov_b32 v102, 0
    v_mov_b32 v103, 0
    v_mov_b32 v104, 0
    v_mov_b32 v105, 0
    v_mov_b32 v106, 0
    v_mov_b32 v107, 0
    v_mov_b32 v108, 0
    v_mov_b32 v109, 0
    v_mov_b32 v110, 0
    v_mov_b32 v111, 0
    v_mov_b32 v112, 0
    v_mov_b32 v113, 0
    v_mov_b32 v114, 0
    v_mov_b32 v115, 0
    v_mov_b32 v116, 0
    v_mov_b32 v117, 0
    v_mov_b32 v118, 0
    v_mov_b32 v119, 0
    v_mov_b32 v120, 0
    v_mov_b32 v121, 0
    v_mov_b32 v122, 0
    v_mov_b32 v123, 0
    v_mov_b32 v124, 0
    v_mov_b32 v125, 0
    v_mov_b32 v126, 0
    v_mov_b32 v127, 0
    v_mov_b32 v12, 0
    v_mov_b32 v13, 0
    v_mov_b32 v14, 0
    v_mov_b32 v15, 0
    s_waitcnt lgkmcnt(0)
    s_mov_b64 exec, 0
    s_bitcmp1_b32 s14, 1
    s_cbranch_scc1 L_tc1
    s_bitcmp1_b32 s14, 0
    s_cbranch_scc1 L_t4
    s_branch L_t2
L_tc1:
    s_bitcmp1_b32 s14, 0
    s_cbranch_scc1 L_tP2
    s_branch L_t5
L_tret:
    s_mov_b64 exec, -1
    s_cmp_eq_u32 s19, 0
    s_cbranch_scc1 L_end
    v_add_u32 v28, s18, v1
    v_add_u32 v29, s31, v1
    v_add_u32 v3, s24, v1
    v_add_u32 v4, s24, v2
    v_add_u32 v6, s23, v6
    v_add_u32 v10, s23, v10
    v_xor_b32 v7, 16, v6
    v_xor_b32 v8, 64, v6
    v_xor_b32 v9, 0x50, v6
    s_add_u32 s16, s16, s15
    s_add_u32 s48, s10, s16
    s_addc_u32 s49, s11, 0
    s_mov_b32 s50, s17
    s_mov_b32 s84, 0
    s_mov_b32 s85, 0x8000
    s_mov_b32 s86, 0x10000
    s_mov_b32 s87, 0x18000
    v_mov_b32 v228, 0x4e800000
    s_add_u32 s82, s25, s15
    s_add_u32 s56, s8, s82
    s_addc_u32 s57, s9, 0
    s_mov_b32 s58, s26
    s_and_b32 s83, s27, 0x3e0000
    s_and_b32 s82, s14, 1
    s_lshl_b32 s82, s82, 16
    v_lshrrev_b32 v229, 2, v0
    v_lshlrev_b32 v229, 12, v229
    v_and_b32 v239, 3, v0
    v_lshl_add_u32 v229, v239, 6, v229
    v_add_u32 v229, s82, v229
    s_setprio 1
    s_cmp_eq_u32 s19, 6
    s_cbranch_scc0 L_pro0
    s_barrier
    buffer_load_dword v239, v229, s[56:59], s83 offen
    ds_read_b128 v[128:131], v28 offset:0
    ds_read_b128 v[160:163], v29 offset:0
    ds_read_b128 v[132:135], v28 offset:16
    ds_read_b128 v[164:167], v29 offset:16
    ds_read_b128 v[136:139], v28 offset:32
    ds_read_b128 v[168:171], v29 offset:32
    ds_read_b128 v[140:143], v28 offset:48
    ds_read_b128 v[172:175], v29 offset:48
    ds_read_b128 v[144:147], v28 offset:64
    ds_read_b128 v[176:179], v29 offset:64
    ds_read_b128 v[148:151], v28 offset:80
    ds_read_b128 v[180:183], v29 offset:80
    ds_read_b128 v[152:155], v28 offset:96
    ds_read_b128 v[184:187], v29 offset:96
    ds_read_b128 v[156:159], v28 offset:112
    ds_read_b128 v[188:191], v29 offset:112
    s_waitcnt lgkmcnt(14)
    v_mfma_f32_32x32x16_bf16 v[48:63], v[160:163], v[128:131], 0
    s_waitcnt lgkmcnt(12)
    v_mfma_f32_32x32x16_bf16 v[48:63], v[164:167], v[132:135], v[48:63]
    s_waitcnt lgkmcnt(10)
    v_mfma_f32_32x32x16_bf16 v[48:63], v[168:171], v[136:139], v[48:63]
    s_waitcnt lgkmcnt(8)
    v_mfma_f32_32x32x16_bf16 v[48:63], v[172:175], v[140:143], v[48:63]
    s_waitcnt lgkmcnt(6)
    v_mfma_f32_32x32x16_bf16 v[48:63], v[176:179], v[144:147], v[48:63]
    s_waitcnt lgkmcnt(4)
    v_mfma_f32_32x32x16_bf16 v[48:63], v[180:183], v[148:151], v[48:63]
    s_waitcnt lgkmcnt(2)
    v_mfma_f32_32x32x16_bf16 v[48:63], v[184:187], v[152:155], v[48:63]
    s_waitcnt lgkmcnt(0)
    v_mfma_f32_32x32x16_bf16 v[48:63], v[188:191], v[156:159], v[48:63]
    s_nop 7
    s_nop 3
    v_mul_f32 v48, s60, v48
    v_mul_f32 v49, s60, v49
    v_exp_f32 v48, v48
    v_mul_f32 v50, s60, v50
    v_exp_f32 v49, v49
    v_mul_f32 v51, s60, v51
    v_exp_f32 v50, v50
    v_mul_f32 v52, s60, v52
    v_exp_f32 v51, v51
    v_cvt_pk_bf16_f32 v20, v48, v49
    v_exp_f32 v52, v52
    v_mul_f32 v53, s60, v53
    v_cvt_pk_bf16_f32 v21, v50, v51
    s_barrier
    ds_read_b128 v[160:163], v29 offset:17024
    ds_read_b128 v[164:167], v29 offset:17040
    ds_read_b128 v[168:171], v29 offset:17056
    ds_read_b128 v[172:175], v29 offset:17072
    ds_read_b128 v[176:179], v29 offset:17088
    ds_read_b128 v[180:183], v29 offset:17104
    ds_read_b128 v[184:187], v29 offset:17120
    ds_read_b128 v[188:191], v29 offset:17136
    s_branch L_b5
L_pro0:
    s_barrier
    buffer_load_dword v239, v229, s[56:59], s83 offen
    ds_read_b128 v[128:131], v28 offset:0
    ds_read_b128 v[160:163], v29 offset:0
    ds_read_b128 v[132:135], v28 offset:16
    ds_read_b128 v[164:167], v29 offset:16
    ds_read_b128 v[136:139], v28 offset:32
    ds_read_b128 v[168:171], v29 offset:32
    ds_read_b128 v[140:143], v28 offset:48
    ds_read_b128 v[172:175], v29 offset:48
    ds_read_b128 v[144:147], v28 offset:64
    ds_read_b128 v[176:179], v29 offset:64
    ds_read_b128 v[148:151], v28 offset:80
    ds_read_b128 v[180:183], v29 offset:80
    ds_read_b128 v[152:155], v28 offset:96
    ds_read_b128 v[184:187], v29 offset:96
    ds_read_b128 v[156:159], v28 offset:112
    ds_read_b128 v[188:191], v29 offset:112
    s_waitcnt lgkmcnt(14)
    v_mfma_f32_32x32x16_bf16 v[32:47], v[160:163], v[128:131], 0
    s_waitcnt lgkmcnt(12)
    v_mfma_f32_32x32x16_bf16 v[32:47], v[164:167], v[132:135], v[32:47]
    s_waitcnt lgkmcnt(10)
    v_mfma_f32_32x32x16_bf16 v[32:47], v[168:171], v[136:139], v[32:47]
    s_waitcnt lgkmcnt(8)
    v_mfma_f32_32x32x16_bf16 v[32:47], v[172:175], v[140:143], v[32:47]
    s_waitcnt lgkmcnt(6)
    v_mfma_f32_32x32x16_bf16 v[32:47], v[176:179], v[144:147], v[32:47]
    s_waitcnt lgkmcnt(4)
    v_mfma_f32_32x32x16_bf16 v[32:47], v[180:183], v[148:151], v[32:47]
    s_waitcnt lgkmcnt(2)
    v_mfma_f32_32x32x16_bf16 v[32:47], v[184:187], v[152:155], v[32:47]
    s_waitcnt lgkmcnt(0)
    v_mfma_f32_32x32x16_bf16 v[32:47], v[188:191], v[156:159], v[32:47]
    s_nop 7
    s_nop 3
    v_mul_f32 v32, s60, v32
    v_mul_f32 v33, s60, v33
    v_exp_f32 v32, v32
    v_mul_f32 v34, s60, v34
    v_exp_f32 v33, v33
    v_mul_f32 v35, s60, v35
    v_exp_f32 v34, v34
    v_mul_f32 v36, s60, v36
    v_exp_f32 v35, v35
    v_cvt_pk_bf16_f32 v20, v32, v33
    v_exp_f32 v36, v36
    v_mul_f32 v37, s60, v37
    v_cvt_pk_bf16_f32 v21, v34, v35
    s_barrier
    ds_read_b128 v[160:163], v29 offset:17024
    ds_read_b128 v[164:167], v29 offset:17040
    ds_read_b128 v[168:171], v29 offset:17056
    ds_read_b128 v[172:175], v29 offset:17072
    ds_read_b128 v[176:179], v29 offset:17088
    ds_read_b128 v[180:183], v29 offset:17104
    ds_read_b128 v[184:187], v29 offset:17120
    ds_read_b128 v[188:191], v29 offset:17136
    s_cmp_eq_u32 s19, 9
    s_cbranch_scc1 L_b2
    s_cmp_eq_u32 s19, 7
    s_cbranch_scc1 L_b4
L_loop:
L_b0:
    s_waitcnt lgkmcnt(4)
    v_mfma_f32_32x32x16_bf16 v[48:63], v[160:163], v[128:131], 0
    ds_read_b64_tr_b16 v[192:193], v4 offset:8320
    ds_read_b64_tr_b16 v[194:195], v4 offset:8832
    v_exp_f32 v37, v37
    v_mul_f32 v38, s60, v38
    v_mfma_f32_32x32x16_bf16 v[48:63], v[164:167], v[132:135], v[48:63]
    ds_read_b64_tr_b16 v[196:197], v4 offset:8384
    ds_read_b64_tr_b16 v[198:199], v4 offset:8896
    v_exp_f32 v38, v38
    v_mul_f32 v39, s60, v39
    v_cvt_pk_bf16_f32 v22, v36, v37
    v_mfma_f32_32x32x16_bf16 v[48:63], v[168:171], v[136:139], v[48:63]
    ds_read_b64_tr_b16 v[200:201], v4 offset:8448
    ds_read_b64_tr_b16 v[202:203], v4 offset:8960
    v_exp_f32 v39, v39
    v_mul_f32 v40, s60, v40
    v_mfma_f32_32x32x16_bf16 v[48:63], v[172:175], v[140:143], v[48:63]
    ds_read_b64_tr_b16 v[204:205], v4 offset:8512
    ds_read_b64_tr_b16 v[206:207], v4 offset:9024
    v_exp_f32 v40, v40
    v_mul_f32 v41, s60, v41
    v_cvt_pk_bf16_f32 v23, v38, v39
    s_waitcnt lgkmcnt(8)
    v_mfma_f32_32x32x16_bf16 v[48:63], v[176:179], v[144:147], v[48:63]
    ds_read_b64_tr_b16 v[208:209], v4 offset:12672
    ds_read_b64_tr_b16 v[210:211], v4 offset:13184
    v_exp_f32 v41, v41
    v_mul_f32 v42, s60, v42
    v_mfma_f32_32x32x16_bf16 v[48:63], v[180:183], v[148:151], v[48:63]
    ds_read_b64_tr_b16 v[212:213], v4 offset:12736
    ds_read_b64_tr_b16 v[214:215], v4 offset:13248
    v_exp_f32 v42, v42
    v_mul_f32 v43, s60, v43
    v_cvt_pk_bf16_f32 v24, v40, v41
    v_mfma_f32_32x32x16_bf16 v[48:63], v[184:187], v[152:155], v[48:63]
    ds_read_b64_tr_b16 v[216:217], v4 offset:12800
    ds_read_b64_tr_b16 v[218:219], v4 offset:13312
    v_exp_f32 v43, v43
    v_mul_f32 v44, s60, v44
    v_mfma_f32_32x32x16_bf16 v[48:63], v[188:191], v[156:159], v[48:63]
    ds_read_b64_tr_b16 v[220:221], v4 offset:12864
    ds_read_b64_tr_b16 v[222:223], v4 offset:13376
    v_exp_f32 v44, v44
    v_mul_f32 v45, s60, v45
    v_cvt_pk_bf16_f32 v25, v42, v43
    s_waitcnt lgkmcnt(8)
    v_mfma_f32_32x32x16_bf16 v[64:79], v[192:195], v[20:23], v[64:79]
    v_exp_f32 v45, v45
    v_mul_f32 v46, s60, v46
    v_mfma_f32_32x32x16_bf16 v[80:95], v[196:199], v[20:23], v[80:95]
    v_exp_f32 v46, v46
    v_mul_f32 v47, s60, v47
    v_cvt_pk_bf16_f32 v26, v44, v45
    v_mfma_f32_32x32x16_bf16 v[96:111], v[200:203], v[20:23], v[96:111]
    v_exp_f32 v47, v47
    v_mul_f32 v48, s60, v48
    v_mul_f32 v49, s60, v49
    v_mfma_f32_32x32x16_bf16 v[112:127], v[204:207], v[20:23], v[112:127]
    s_waitcnt lgkmcnt(0)
    s_barrier
    v_exp_f32 v48, v48
    v_cvt_pk_bf16_f32 v27, v46, v47
    v_mfma_f32_16x16x32_bf16 v[12:15], v[16:19], v[20:23], v[12:15]
    ds_read_b128 v[160:163], v3 offset:34048
    ds_read_b128 v[164:167], v3 offset:34064
    v_mfma_f32_32x32x16_bf16 v[64:79], v[208:211], v[24:27], v[64:79]
    ds_read_b128 v[168:171], v3 offset:34080
    ds_read_b128 v[172:175], v3 offset:34096
    v_exp_f32 v49, v49
    v_mul_f32 v50, s60, v50
    v_mfma_f32_32x32x16_bf16 v[80:95], v[212:215], v[24:27], v[80:95]
    ds_read_b128 v[176:179], v3 offset:34112
    ds_read_b128 v[180:183], v3 offset:34128
    v_exp_f32 v50, v50
    v_mul_f32 v51, s60, v51
    v_cvt_pk_bf16_f32 v20, v48, v49
    v_mfma_f32_32x32x16_bf16 v[96:111], v[216:219], v[24:27], v[96:111]
    ds_read_b128 v[184:187], v3 offset:34144
    v_exp_f32 v51, v51
    v_mul_f32 v52, s60, v52
    v_mfma_f32_32x32x16_bf16 v[112:127], v[220:223], v[24:27], v[112:127]
    ds_read_b128 v[188:191], v3 offset:34160
    v_exp_f32 v52, v52
    v_mul_f32 v53, s60, v53
    v_cvt_pk_bf16_f32 v21, v50, v51
    v_mfma_f32_16x16x32_bf16 v[12:15], v[16:19], v[24:27], v[12:15]
L_b1:
    s_waitcnt lgkmcnt(4)
    v_mfma_f32_32x32x16_bf16 v[32:47], v[160:163], v[128:131], 0
    ds_read_b64_tr_b16 v[192:193], v4 offset:25344
    ds_read_b64_tr_b16 v[194:195], v4 offset:25856
    v_exp_f32 v53, v53
    v_mul_f32 v54, s60, v54
    v_mfma_f32_32x32x16_bf16 v[32:47], v[164:167], v[132:135], v[32:47]
    ds_read_b64_tr_b16 v[196:197], v4 offset:25408
    ds_read_b64_tr_b16 v[198:199], v4 offset:25920
    v_exp_f32 v54, v54
    v_mul_f32 v55, s60, v55
    v_cvt_pk_bf16_f32 v22, v52, v53
    v_mfma_f32_32x32x16_bf16 v[32:47], v[168:171], v[136:139], v[32:47]
    ds_read_b64_tr_b16 v[200:201], v4 offset:25472
    ds_read_b64_tr_b16 v[202:203], v4 offset:25984
L_tP1:
    s_cbranch_execz L_tret
    v_exp_f32 v55, v55
    v_mul_f32 v56, s60, v56
    v_mfma_f32_32x32x16_bf16 v[32:47], v[172:175], v[140:143], v[32:47]
    ds_read_b64_tr_b16 v[204:205], v4 offset:25536
    ds_read_b64_tr_b16 v[206:207], v4 offset:26048
    v_exp_f32 v56, v56
    v_mul_f32 v57, s60, v57
    v_cvt_pk_bf16_f32 v23, v54, v55
    s_waitcnt lgkmcnt(8)
    v_mfma_f32_32x32x16_bf16 v[32:47], v[176:179], v[144:147], v[32:47]
    ds_read_b64_tr_b16 v[208:209], v4 offset:29696
    ds_read_b64_tr_b16 v[210:211], v4 offset:30208
    v_exp_f32 v57, v57
    v_mul_f32 v58, s60, v58
    v_mfma_f32_32x32x16_bf16 v[32:47], v[180:183], v[148:151], v[32:47]
    ds_read_b64_tr_b16 v[212:213], v4 offset:29760
    ds_read_b64_tr_b16 v[214:215], v4 offset:30272
    v_exp_f32 v58, v58
    v_mul_f32 v59, s60, v59
    v_cvt_pk_bf16_f32 v24, v56, v57
    v_mfma_f32_32x32x16_bf16 v[32:47], v[184:187], v[152:155], v[32:47]
    ds_read_b64_tr_b16 v[216:217], v4 offset:29824
    ds_read_b64_tr_b16 v[218:219], v4 offset:30336
    v_exp_f32 v59, v59
    v_mul_f32 v60, s60, v60
    v_mfma_f32_32x32x16_bf16 v[32:47], v[188:191], v[156:159], v[32:47]
    ds_read_b64_tr_b16 v[220:221], v4 offset:29888
    ds_read_b64_tr_b16 v[222:223], v4 offset:30400
    v_exp_f32 v60, v60
    v_mul_f32 v61, s60, v61
    v_cvt_pk_bf16_f32 v25, v58, v59
    s_waitcnt lgkmcnt(8)
    v_mfma_f32_32x32x16_bf16 v[64:79], v[192:195], v[20:23], v[64:79]
    v_exp_f32 v61, v61
    v_mul_f32 v62, s60, v62
    v_mfma_f32_32x32x16_bf16 v[80:95], v[196:199], v[20:23], v[80:95]
    v_exp_f32 v62, v62
    v_mul_f32 v63, s60, v63
    v_cvt_pk_bf16_f32 v26, v60, v61
    v_mfma_f32_32x32x16_bf16 v[96:111], v[200:203], v[20:23], v[96:111]
    v_exp_f32 v63, v63
    v_mul_f32 v32, s60, v32
    v_mul_f32 v33, s60, v33
    v_mfma_f32_32x32x16_bf16 v[112:127], v[204:207], v[20:23], v[112:127]
    s_waitcnt lgkmcnt(0)
    s_barrier
    v_exp_f32 v32, v32
    v_cvt_pk_bf16_f32 v27, v62, v63
    v_mfma_f32_16x16x32_bf16 v[12:15], v[16:19], v[20:23], v[12:15]
    ds_read_b128 v[160:163], v3 offset:51072
    ds_read_b128 v[164:167], v3 offset:51088
    v_mfma_f32_32x32x16_bf16 v[64:79], v[208:211], v[24:27], v[64:79]
    ds_read_b128 v[168:171], v3 offset:51104
    ds_read_b128 v[172:175], v3 offset:51120
    v_exp_f32 v33, v33
    v_mul_f32 v34, s60, v34
    v_mfma_f32_32x32x16_bf16 v[80:95], v[212:215], v[24:27], v[80:95]
    ds_read_b128 v[176:179], v3 offset:51136
    ds_read_b128 v[180:183], v3 offset:51152
    v_exp_f32 v34, v34
    v_mul_f32 v35, s60, v35
    v_cvt_pk_bf16_f32 v20, v32, v33
    v_mfma_f32_32x32x16_bf16 v[96:111], v[216:219], v[24:27], v[96:111]
    ds_read_b128 v[184:187], v3 offset:51168
    v_exp_f32 v35, v35
    v_mul_f32 v36, s60, v36
    v_mfma_f32_32x32x16_bf16 v[112:127], v[220:223], v[24:27], v[112:127]
    ds_read_b128 v[188:191], v3 offset:51184
    v_exp_f32 v36, v36
    v_mul_f32 v37, s60, v37
    v_cvt_pk_bf16_f32 v21, v34, v35
    v_mfma_f32_16x16x32_bf16 v[12:15], v[16:19], v[24:27], v[12:15]
L_t2:
    s_cbranch_execz L_tP1
L_b2:
    s_waitcnt lgkmcnt(4)
    v_mfma_f32_32x32x16_bf16 v[48:63], v[160:163], v[128:131], 0
    ds_read_b64_tr_b16 v[192:193], v4 offset:42368
    ds_read_b64_tr_b16 v[194:195], v4 offset:42880
    v_exp_f32 v37, v37
    v_mul_f32 v38, s60, v38
    v_mfma_f32_32x32x16_bf16 v[48:63], v[164:167], v[132:135], v[48:63]
    ds_read_b64_tr_b16 v[196:197], v4 offset:42432
    ds_read_b64_tr_b16 v[198:199], v4 offset:42944
    v_exp_f32 v38, v38
    v_mul_f32 v39, s60, v39
    v_cvt_pk_bf16_f32 v22, v36, v37
    v_mfma_f32_32x32x16_bf16 v[48:63], v[168:171], v[136:139], v[48:63]
    ds_read_b64_tr_b16 v[200:201], v4 offset:42496
    ds_read_b64_tr_b16 v[202:203], v4 offset:43008
    v_exp_f32 v39, v39
    v_mul_f32 v40, s60, v40
    v_mfma_f32_32x32x16_bf16 v[48:63], v[172:175], v[140:143], v[48:63]
    ds_read_b64_tr_b16 v[204:205], v4 offset:42560
    ds_read_b64_tr_b16 v[206:207], v4 offset:43072
    v_exp_f32 v40, v40
    v_mul_f32 v41, s60, v41
    v_cvt_pk_bf16_f32 v23, v38, v39
    s_waitcnt lgkmcnt(8)
    v_mfma_f32_32x32x16_bf16 v[48:63], v[176:179], v[144:147], v[48:63]
    ds_read_b64_tr_b16 v[208:209], v4 offset:46720
    ds_read_b64_tr_b16 v[210:211], v4 offset:47232
    v_exp_f32 v41, v41
    v_mul_f32 v42, s60, v42
    v_mfma_f32_32x32x16_bf16 v[48:63], v[180:183], v[148:151], v[48:63]
    ds_read_b64_tr_b16 v[212:213], v4 offset:46784
    ds_read_b64_tr_b16 v[214:215], v4 offset:47296
    v_exp_f32 v42, v42
    v_mul_f32 v43, s60, v43
    v_cvt_pk_bf16_f32 v24, v40, v41
    v_mfma_f32_32x32x16_bf16 v[48:63], v[184:187], v[152:155], v[48:63]
    ds_read_b64_tr_b16 v[216:217], v4 offset:46848
    ds_read_b64_tr_b16 v[218:219], v4 offset:47360
    v_exp_f32 v43, v43
    v_mul_f32 v44, s60, v44
    v_mfma_f32_32x32x16_bf16 v[48:63], v[188:191], v[156:159], v[48:63]
    ds_read_b64_tr_b16 v[220:221], v4 offset:46912
    ds_read_b64_tr_b16 v[222:223], v4 offset:47424
    v_exp_f32 v44, v44
    v_mul_f32 v45, s60, v45
    v_cvt_pk_bf16_f32 v25, v42, v43
    s_waitcnt lgkmcnt(8)
    v_mfma_f32_32x32x16_bf16 v[64:79], v[192:195], v[20:23], v[64:79]
    v_exp_f32 v45, v45
    v_mul_f32 v46, s60, v46
    v_mfma_f32_32x32x16_bf16 v[80:95], v[196:199], v[20:23], v[80:95]
    v_exp_f32 v46, v46
    v_mul_f32 v47, s60, v47
    v_cvt_pk_bf16_f32 v26, v44, v45
    v_mfma_f32_32x32x16_bf16 v[96:111], v[200:203], v[20:23], v[96:111]
    v_exp_f32 v47, v47
    v_mul_f32 v48, s60, v48
    v_mul_f32 v49, s60, v49
    v_mfma_f32_32x32x16_bf16 v[112:127], v[204:207], v[20:23], v[112:127]
    s_waitcnt lgkmcnt(0)
    s_barrier
    v_exp_f32 v48, v48
    v_cvt_pk_bf16_f32 v27, v46, v47
    v_mfma_f32_16x16x32_bf16 v[12:15], v[16:19], v[20:23], v[12:15]
    ds_read_b128 v[160:163], v3 offset:0
    ds_read_b128 v[164:167], v3 offset:16
    v_mfma_f32_32x32x16_bf16 v[64:79], v[208:211], v[24:27], v[64:79]
    ds_read_b128 v[168:171], v3 offset:32
    ds_read_b128 v[172:175], v3 offset:48
    v_exp_f32 v49, v49
    v_mul_f32 v50, s60, v50
    v_mfma_f32_32x32x16_bf16 v[80:95], v[212:215], v[24:27], v[80:95]
    ds_read_b128 v[176:179], v3 offset:64
    ds_read_b128 v[180:183], v3 offset:80
    v_exp_f32 v50, v50
    v_mul_f32 v51, s60, v51
    v_cvt_pk_bf16_f32 v20, v48, v49
    v_mfma_f32_32x32x16_bf16 v[96:111], v[216:219], v[24:27], v[96:111]
    ds_read_b128 v[184:187], v3 offset:96
    v_exp_f32 v51, v51
    v_mul_f32 v52, s60, v52
    v_mfma_f32_32x32x16_bf16 v[112:127], v[220:223], v[24:27], v[112:127]
    ds_read_b128 v[188:191], v3 offset:112
    v_exp_f32 v52, v52
    v_mul_f32 v53, s60, v53
    v_cvt_pk_bf16_f32 v21, v50, v51
    v_mfma_f32_16x16x32_bf16 v[12:15], v[16:19], v[24:27], v[12:15]
L_b3:
    s_waitcnt lgkmcnt(4)
    v_mfma_f32_32x32x16_bf16 v[32:47], v[160:163], v[128:131], 0
    ds_read_b64_tr_b16 v[192:193], v4 offset:59392
    ds_read_b64_tr_b16 v[194:195], v4 offset:59904
    v_exp_f32 v53, v53
    v_mul_f32 v54, s60, v54
    v_mfma_f32_32x32x16_bf16 v[32:47], v[164:167], v[132:135], v[32:47]
    ds_read_b64_tr_b16 v[196:197], v4 offset:59456
    ds_read_b64_tr_b16 v[198:199], v4 offset:59968
    v_exp_f32 v54, v54
    v_mul_f32 v55, s60, v55
    v_cvt_pk_bf16_f32 v22, v52, v53
    v_mfma_f32_32x32x16_bf16 v[32:47], v[168:171], v[136:139], v[32:47]
    ds_read_b64_tr_b16 v[200:201], v4 offset:59520
    ds_read_b64_tr_b16 v[202:203], v4 offset:60032
    v_exp_f32 v55, v55
    v_mul_f32 v56, s60, v56
    v_mfma_f32_32x32x16_bf16 v[32:47], v[172:175], v[140:143], v[32:47]
    ds_read_b64_tr_b16 v[204:205], v4 offset:59584
    ds_read_b64_tr_b16 v[206:207], v4 offset:60096
    v_exp_f32 v56, v56
    v_mul_f32 v57, s60, v57
    v_cvt_pk_bf16_f32 v23, v54, v55
    s_waitcnt lgkmcnt(8)
    v_mfma_f32_32x32x16_bf16 v[32:47], v[176:179], v[144:147], v[32:47]
    ds_read_b64_tr_b16 v[208:209], v4 offset:63744
    ds_read_b64_tr_b16 v[210:211], v4 offset:64256
    v_exp_f32 v57, v57
    v_mul_f32 v58, s60, v58
    v_mfma_f32_32x32x16_bf16 v[32:47], v[180:183], v[148:151], v[32:47]
    ds_read_b64_tr_b16 v[212:213], v4 offset:63808
    ds_read_b64_tr_b16 v[214:215], v4 offset:64320
    v_exp_f32 v58, v58
    v_mul_f32 v59, s60, v59
    v_cvt_pk_bf16_f32 v24, v56, v57
    v_mfma_f32_32x32x16_bf16 v[32:47], v[184:187], v[152:155], v[32:47]
    ds_read_b64_tr_b16 v[216:217], v4 offset:63872
    ds_read_b64_tr_b16 v[218:219], v4 offset:64384
    v_exp_f32 v59, v59
    v_mul_f32 v60, s60, v60
    v_mfma_f32_32x32x16_bf16 v[32:47], v[188:191], v[156:159], v[32:47]
    ds_read_b64_tr_b16 v[220:221], v4 offset:63936
    ds_read_b64_tr_b16 v[222:223], v4 offset:64448
    v_exp_f32 v60, v60
    v_mul_f32 v61, s60, v61
    v_cvt_pk_bf16_f32 v25, v58, v59
    s_waitcnt lgkmcnt(8)
    v_mfma_f32_32x32x16_bf16 v[64:79], v[192:195], v[20:23], v[64:79]
    v_exp_f32 v61, v61
    v_mul_f32 v62, s60, v62
    v_mfma_f32_32x32x16_bf16 v[80:95], v[196:199], v[20:23], v[80:95]
    v_exp_f32 v62, v62
    v_mul_f32 v63, s60, v63
    v_cvt_pk_bf16_f32 v26, v60, v61
    v_mfma_f32_32x32x16_bf16 v[96:111], v[200:203], v[20:23], v[96:111]
    v_exp_f32 v63, v63
    v_mul_f32 v32, s60, v32
    v_mul_f32 v33, s60, v33
    v_mfma_f32_32x32x16_bf16 v[112:127], v[204:207], v[20:23], v[112:127]
    s_waitcnt lgkmcnt(0)
    s_barrier
    v_exp_f32 v32, v32
    v_cvt_pk_bf16_f32 v27, v62, v63
    v_mfma_f32_16x16x32_bf16 v[12:15], v[16:19], v[20:23], v[12:15]
    ds_read_b128 v[160:163], v3 offset:17024
    ds_read_b128 v[164:167], v3 offset:17040
    v_mfma_f32_32x32x16_bf16 v[64:79], v[208:211], v[24:27], v[64:79]
    ds_read_b128 v[168:171], v3 offset:17056
    ds_read_b128 v[172:175], v3 offset:17072
    v_exp_f32 v33, v33
    v_mul_f32 v34, s60, v34
    v_mfma_f32_32x32x16_bf16 v[80:95], v[212:215], v[24:27], v[80:95]
    ds_read_b128 v[176:179], v3 offset:17088
    ds_read_b128 v[180:183], v3 offset:17104
    v_exp_f32 v34, v34
    v_mul_f32 v35, s60, v35
    v_cvt_pk_bf16_f32 v20, v32, v33
    v_mfma_f32_32x32x16_bf16 v[96:111], v[216:219], v[24:27], v[96:111]
    ds_read_b128 v[184:187], v3 offset:17120
    v_exp_f32 v35, v35
    v_mul_f32 v36, s60, v36
    v_mfma_f32_32x32x16_bf16 v[112:127], v[220:223], v[24:27], v[112:127]
    ds_read_b128 v[188:191], v3 offset:17136
    v_exp_f32 v36, v36
    v_mul_f32 v37, s60, v37
    v_cvt_pk_bf16_f32 v21, v34, v35
    v_mfma_f32_16x16x32_bf16 v[12:15], v[16:19], v[24:27], v[12:15]
L_t4:
    s_cbranch_execz L_tS
L_b4:
    s_waitcnt lgkmcnt(4)
    v_mfma_f32_32x32x16_bf16 v[48:63], v[160:163], v[128:131], 0
    ds_read_b64_tr_b16 v[192:193], v4 offset:8320
    ds_read_b64_tr_b16 v[194:195], v4 offset:8832
    v_exp_f32 v37, v37
    v_mul_f32 v38, s60, v38
    v_mfma_f32_32x32x16_bf16 v[48:63], v[164:167], v[132:135], v[48:63]
    ds_read_b64_tr_b16 v[196:197], v4 offset:8384
    ds_read_b64_tr_b16 v[198:199], v4 offset:8896
    v_exp_f32 v38, v38
    v_mul_f32 v39, s60, v39
    v_cvt_pk_bf16_f32 v22, v36, v37
    v_mfma_f32_32x32x16_bf16 v[48:63], v[168:171], v[136:139], v[48:63]
    ds_read_b64_tr_b16 v[200:201], v4 offset:8448
    ds_read_b64_tr_b16 v[202:203], v4 offset:8960
    v_exp_f32 v39, v39
    v_mul_f32 v40, s60, v40
    v_mfma_f32_32x32x16_bf16 v[48:63], v[172:175], v[140:143], v[48:63]
    ds_read_b64_tr_b16 v[204:205], v4 offset:8512
    ds_read_b64_tr_b16 v[206:207], v4 offset:9024
    v_exp_f32 v40, v40
    v_mul_f32 v41, s60, v41
    v_cvt_pk_bf16_f32 v23, v38, v39
    s_waitcnt lgkmcnt(8)
    v_mfma_f32_32x32x16_bf16 v[48:63], v[176:179], v[144:147], v[48:63]
    ds_read_b64_tr_b16 v[208:209], v4 offset:12672
    ds_read_b64_tr_b16 v[210:211], v4 offset:13184
    v_exp_f32 v41, v41
    v_mul_f32 v42, s60, v42
    v_mfma_f32_32x32x16_bf16 v[48:63], v[180:183], v[148:151], v[48:63]
    ds_read_b64_tr_b16 v[212:213], v4 offset:12736
    ds_read_b64_tr_b16 v[214:215], v4 offset:13248
    v_exp_f32 v42, v42
    v_mul_f32 v43, s60, v43
    v_cvt_pk_bf16_f32 v24, v40, v41
    v_mfma_f32_32x32x16_bf16 v[48:63], v[184:187], v[152:155], v[48:63]
    ds_read_b64_tr_b16 v[216:217], v4 offset:12800
    ds_read_b64_tr_b16 v[218:219], v4 offset:13312
    v_exp_f32 v43, v43
    v_mul_f32 v44, s60, v44
    v_mfma_f32_32x32x16_bf16 v[48:63], v[188:191], v[156:159], v[48:63]
    ds_read_b64_tr_b16 v[220:221], v4 offset:12864
    ds_read_b64_tr_b16 v[222:223], v4 offset:13376
    v_exp_f32 v44, v44
    v_mul_f32 v45, s60, v45
    v_cvt_pk_bf16_f32 v25, v42, v43
    s_waitcnt lgkmcnt(8)
    v_mfma_f32_32x32x16_bf16 v[64:79], v[192:195], v[20:23], v[64:79]
    v_exp_f32 v45, v45
    v_mul_f32 v46, s60, v46
    v_mfma_f32_32x32x16_bf16 v[80:95], v[196:199], v[20:23], v[80:95]
    v_exp_f32 v46, v46
    v_mul_f32 v47, s60, v47
    v_cvt_pk_bf16_f32 v26, v44, v45
    v_mfma_f32_32x32x16_bf16 v[96:111], v[200:203], v[20:23], v[96:111]
    v_exp_f32 v47, v47
    v_mul_f32 v48, s60, v48
    v_mul_f32 v49, s60, v49
    v_mfma_f32_32x32x16_bf16 v[112:127], v[204:207], v[20:23], v[112:127]
    s_waitcnt lgkmcnt(0)
    s_barrier
    v_exp_f32 v48, v48
    v_cvt_pk_bf16_f32 v27, v46, v47
    v_mfma_f32_16x16x32_bf16 v[12:15], v[16:19], v[20:23], v[12:15]
    ds_read_b128 v[160:163], v3 offset:34048
    ds_read_b128 v[164:167], v3 offset:34064
    v_mfma_f32_32x32x16_bf16 v[64:79], v[208:211], v[24:27], v[64:79]
    ds_read_b128 v[168:171], v3 offset:34080
    ds_read_b128 v[172:175], v3 offset:34096
    v_exp_f32 v49, v49
    v_mul_f32 v50, s60, v50
    v_mfma_f32_32x32x16_bf16 v[80:95], v[212:215], v[24:27], v[80:95]
    ds_read_b128 v[176:179], v3 offset:34112
    ds_read_b128 v[180:183], v3 offset:34128
    v_exp_f32 v50, v50
    v_mul_f32 v51, s60, v51
    v_cvt_pk_bf16_f32 v20, v48, v49
    v_mfma_f32_32x32x16_bf16 v[96:111], v[216:219], v[24:27], v[96:111]
    ds_read_b128 v[184:187], v3 offset:34144
    v_exp_f32 v51, v51
    v_mul_f32 v52, s60, v52
    v_mfma_f32_32x32x16_bf16 v[112:127], v[220:223], v[24:27], v[112:127]
    ds_read_b128 v[188:191], v3 offset:34160
    v_exp_f32 v52, v52
    v_mul_f32 v53, s60, v53
    v_cvt_pk_bf16_f32 v21, v50, v51
    v_mfma_f32_16x16x32_bf16 v[12:15], v[16:19], v[24:27], v[12:15]
L_t5:
    s_cbranch_execz L_tret
L_b5:
    s_waitcnt lgkmcnt(4)
    v_mfma_f32_32x32x16_bf16 v[32:47], v[160:163], v[128:131], 0
    ds_read_b64_tr_b16 v[192:193], v4 offset:25344
    ds_read_b64_tr_b16 v[194:195], v4 offset:25856
    v_exp_f32 v53, v53
    v_mul_f32 v54, s60, v54
    v_mfma_f32_32x32x16_bf16 v[32:47], v[164:167], v[132:135], v[32:47]
    ds_read_b64_tr_b16 v[196:197], v4 offset:25408
    ds_read_b64_tr_b16 v[198:199], v4 offset:25920
    v_exp_f32 v54, v54
    v_mul_f32 v55, s60, v55
    v_cvt_pk_bf16_f32 v22, v52, v53
    v_mfma_f32_32x32x16_bf16 v[32:47], v[168:171], v[136:139], v[32:47]
    ds_read_b64_tr_b16 v[200:201], v4 offset:25472
    ds_read_b64_tr_b16 v[202:203], v4 offset:25984
    v_exp_f32 v55, v55
    v_mul_f32 v56, s60, v56
    v_mfma_f32_32x32x16_bf16 v[32:47], v[172:175], v[140:143], v[32:47]
    ds_read_b64_tr_b16 v[204:205], v4 offset:25536
    ds_read_b64_tr_b16 v[206:207], v4 offset:26048
    v_exp_f32 v56, v56
    v_mul_f32 v57, s60, v57
    v_cvt_pk_bf16_f32 v23, v54, v55
    s_waitcnt lgkmcnt(8)
    v_mfma_f32_32x32x16_bf16 v[32:47], v[176:179], v[144:147], v[32:47]
    ds_read_b64_tr_b16 v[208:209], v4 offset:29696
    ds_read_b64_tr_b16 v[210:211], v4 offset:30208
    v_exp_f32 v57, v57
    v_mul_f32 v58, s60, v58
    v_mfma_f32_32x32x16_bf16 v[32:47], v[180:183], v[148:151], v[32:47]
    ds_read_b64_tr_b16 v[212:213], v4 offset:29760
    ds_read_b64_tr_b16 v[214:215], v4 offset:30272
    v_exp_f32 v58, v58
    v_mul_f32 v59, s60, v59
    v_cvt_pk_bf16_f32 v24, v56, v57
    v_mfma_f32_32x32x16_bf16 v[32:47], v[184:187], v[152:155], v[32:47]
    ds_read_b64_tr_b16 v[216:217], v4 offset:29824
    ds_read_b64_tr_b16 v[218:219], v4 offset:30336
    v_exp_f32 v59, v59
    v_mul_f32 v60, s60, v60
    v_mfma_f32_32x32x16_bf16 v[32:47], v[188:191], v[156:159], v[32:47]
    ds_read_b64_tr_b16 v[220:221], v4 offset:29888
    ds_read_b64_tr_b16 v[222:223], v4 offset:30400
    v_exp_f32 v60, v60
    v_mul_f32 v61, s60, v61
    v_cvt_pk_bf16_f32 v25, v58, v59
    s_waitcnt lgkmcnt(8)
    v_mfma_f32_32x32x16_bf16 v[64:79], v[192:195], v[20:23], v[64:79]
    v_exp_f32 v61, v61
    v_mul_f32 v62, s60, v62
    v_mfma_f32_32x32x16_bf16 v[80:95], v[196:199], v[20:23], v[80:95]
    v_exp_f32 v62, v62
    v_mul_f32 v63, s60, v63
    v_cvt_pk_bf16_f32 v26, v60, v61
    v_mfma_f32_32x32x16_bf16 v[96:111], v[200:203], v[20:23], v[96:111]
    v_exp_f32 v63, v63
    v_mul_f32 v32, s60, v32
    v_mul_f32 v33, s60, v33
    v_mfma_f32_32x32x16_bf16 v[112:127], v[204:207], v[20:23], v[112:127]
    s_waitcnt lgkmcnt(0)
    s_barrier
    v_exp_f32 v32, v32
    v_cvt_pk_bf16_f32 v27, v62, v63
    v_mfma_f32_16x16x32_bf16 v[12:15], v[16:19], v[20:23], v[12:15]
    ds_read_b128 v[160:163], v3 offset:51072
    ds_read_b128 v[164:167], v3 offset:51088
    v_mfma_f32_32x32x16_bf16 v[64:79], v[208:211], v[24:27], v[64:79]
    ds_read_b128 v[168:171], v3 offset:51104
    ds_read_b128 v[172:175], v3 offset:51120
    v_exp_f32 v33, v33
    v_mul_f32 v34, s60, v34
    v_mfma_f32_32x32x16_bf16 v[80:95], v[212:215], v[24:27], v[80:95]
    ds_read_b128 v[176:179], v3 offset:51136
    ds_read_b128 v[180:183], v3 offset:51152
    v_exp_f32 v34, v34
    v_mul_f32 v35, s60, v35
    v_cvt_pk_bf16_f32 v20, v32, v33
    v_mfma_f32_32x32x16_bf16 v[96:111], v[216:219], v[24:27], v[96:111]
    ds_read_b128 v[184:187], v3 offset:51168
    v_exp_f32 v35, v35
    v_mul_f32 v36, s60, v36
    v_mfma_f32_32x32x16_bf16 v[112:127], v[220:223], v[24:27], v[112:127]
    ds_read_b128 v[188:191], v3 offset:51184
    v_exp_f32 v36, v36
    v_mul_f32 v37, s60, v37
    v_cvt_pk_bf16_f32 v21, v34, v35
    v_mfma_f32_16x16x32_bf16 v[12:15], v[16:19], v[24:27], v[12:15]
L_b6:
    s_waitcnt lgkmcnt(4)
    v_mfma_f32_32x32x16_bf16 v[48:63], v[160:163], v[128:131], 0
    ds_read_b64_tr_b16 v[192:193], v4 offset:42368
    ds_read_b64_tr_b16 v[194:195], v4 offset:42880
    v_exp_f32 v37, v37
    v_mul_f32 v38, s60, v38
    v_mfma_f32_32x32x16_bf16 v[48:63], v[164:167], v[132:135], v[48:63]
    ds_read_b64_tr_b16 v[196:197], v4 offset:42432
    ds_read_b64_tr_b16 v[198:199], v4 offset:42944
    v_exp_f32 v38, v38
    v_mul_f32 v39, s60, v39
    v_cvt_pk_bf16_f32 v22, v36, v37
    v_mfma_f32_32x32x16_bf16 v[48:63], v[168:171], v[136:139], v[48:63]
    ds_read_b64_tr_b16 v[200:201], v4 offset:42496
    ds_read_b64_tr_b16 v[202:203], v4 offset:43008
    v_exp_f32 v39, v39
    v_mul_f32 v40, s60, v40
    v_mfma_f32_32x32x16_bf16 v[48:63], v[172:175], v[140:143], v[48:63]
    ds_read_b64_tr_b16 v[204:205], v4 offset:42560
    ds_read_b64_tr_b16 v[206:207], v4 offset:43072
    v_exp_f32 v40, v40
    v_mul_f32 v41, s60, v41
    v_cvt_pk_bf16_f32 v23, v38, v39
    s_waitcnt lgkmcnt(8)
    v_mfma_f32_32x32x16_bf16 v[48:63], v[176:179], v[144:147], v[48:63]
    ds_read_b64_tr_b16 v[208:209], v4 offset:46720
    ds_read_b64_tr_b16 v[210:211], v4 offset:47232
    v_exp_f32 v41, v41
    v_mul_f32 v42, s60, v42
    v_mfma_f32_32x32x16_bf16 v[48:63], v[180:183], v[148:151], v[48:63]
    ds_read_b64_tr_b16 v[212:213], v4 offset:46784
    ds_read_b64_tr_b16 v[214:215], v4 offset:47296
    v_exp_f32 v42, v42
    v_mul_f32 v43, s60, v43
    v_cvt_pk_bf16_f32 v24, v40, v41
    v_mfma_f32_32x32x16_bf16 v[48:63], v[184:187], v[152:155], v[48:63]
    ds_read_b64_tr_b16 v[216:217], v4 offset:46848
    ds_read_b64_tr_b16 v[218:219], v4 offset:47360
    v_exp_f32 v43, v43
    v_mul_f32 v44, s60, v44
    v_mfma_f32_32x32x16_bf16 v[48:63], v[188:191], v[156:159], v[48:63]
    ds_read_b64_tr_b16 v[220:221], v4 offset:46912
    ds_read_b64_tr_b16 v[222:223], v4 offset:47424
    v_exp_f32 v44, v44
    v_mul_f32 v45, s60, v45
    v_cvt_pk_bf16_f32 v25, v42, v43
    s_waitcnt lgkmcnt(8)
    v_mfma_f32_32x32x16_bf16 v[64:79], v[192:195], v[20:23], v[64:79]
    v_exp_f32 v45, v45
    v_mul_f32 v46, s60, v46
    v_mfma_f32_32x32x16_bf16 v[80:95], v[196:199], v[20:23], v[80:95]
    v_exp_f32 v46, v46
    v_mul_f32 v47, s60, v47
    v_cvt_pk_bf16_f32 v26, v44, v45
    v_mfma_f32_32x32x16_bf16 v[96:111], v[200:203], v[20:23], v[96:111]
    v_exp_f32 v47, v47
    v_mul_f32 v48, s60, v48
    v_mul_f32 v49, s60, v49
    v_mfma_f32_32x32x16_bf16 v[112:127], v[204:207], v[20:23], v[112:127]
    s_waitcnt lgkmcnt(0)
    s_barrier
    v_exp_f32 v48, v48
    v_cvt_pk_bf16_f32 v27, v46, v47
    v_mfma_f32_16x16x32_bf16 v[12:15], v[16:19], v[20:23], v[12:15]
    ds_read_b128 v[160:163], v3 offset:0
    ds_read_b128 v[164:167], v3 offset:16
    v_mfma_f32_32x32x16_bf16 v[64:79], v[208:211], v[24:27], v[64:79]
    ds_read_b128 v[168:171], v3 offset:32
    ds_read_b128 v[172:175], v3 offset:48
    v_exp_f32 v49, v49
    v_mul_f32 v50, s60, v50
    v_mfma_f32_32x32x16_bf16 v[80:95], v[212:215], v[24:27], v[80:95]
    ds_read_b128 v[176:179], v3 offset:64
    ds_read_b128 v[180:183], v3 offset:80
    v_exp_f32 v50, v50
    v_mul_f32 v51, s60, v51
    v_cvt_pk_bf16_f32 v20, v48, v49
    v_mfma_f32_32x32x16_bf16 v[96:111], v[216:219], v[24:27], v[96:111]
    ds_read_b128 v[184:187], v3 offset:96
    v_exp_f32 v51, v51
    v_mul_f32 v52, s60, v52
    v_mfma_f32_32x32x16_bf16 v[112:127], v[220:223], v[24:27], v[112:127]
    ds_read_b128 v[188:191], v3 offset:112
    v_exp_f32 v52, v52
    v_mul_f32 v53, s60, v53
    v_cvt_pk_bf16_f32 v21, v50, v51
    v_mfma_f32_16x16x32_bf16 v[12:15], v[16:19], v[24:27], v[12:15]
L_b7:
    s_waitcnt lgkmcnt(4)
    v_mfma_f32_32x32x16_bf16 v[32:47], v[160:163], v[128:131], 0
    ds_read_b64_tr_b16 v[192:193], v4 offset:59392
    ds_read_b64_tr_b16 v[194:195], v4 offset:59904
    v_exp_f32 v53, v53
    v_mul_f32 v54, s60, v54
    v_mfma_f32_32x32x16_bf16 v[32:47], v[164:167], v[132:135], v[32:47]
    ds_read_b64_tr_b16 v[196:197], v4 offset:59456
    ds_read_b64_tr_b16 v[198:199], v4 offset:59968
    v_exp_f32 v54, v54
    v_mul_f32 v55, s60, v55
    v_cvt_pk_bf16_f32 v22, v52, v53
    v_mfma_f32_32x32x16_bf16 v[32:47], v[168:171], v[136:139], v[32:47]
    ds_read_b64_tr_b16 v[200:201], v4 offset:59520
    ds_read_b64_tr_b16 v[202:203], v4 offset:60032
    v_exp_f32 v55, v55
    v_mul_f32 v56, s60, v56
    v_mfma_f32_32x32x16_bf16 v[32:47], v[172:175], v[140:143], v[32:47]
    ds_read_b64_tr_b16 v[204:205], v4 offset:59584
    ds_read_b64_tr_b16 v[206:207], v4 offset:60096
    v_exp_f32 v56, v56
    v_mul_f32 v57, s60, v57
    v_cvt_pk_bf16_f32 v23, v54, v55
    s_waitcnt lgkmcnt(8)
    v_mfma_f32_32x32x16_bf16 v[32:47], v[176:179], v[144:147], v[32:47]
    ds_read_b64_tr_b16 v[208:209], v4 offset:63744
    ds_read_b64_tr_b16 v[210:211], v4 offset:64256
    v_exp_f32 v57, v57
    v_mul_f32 v58, s60, v58
    v_mfma_f32_32x32x16_bf16 v[32:47], v[180:183], v[148:151], v[32:47]
    ds_read_b64_tr_b16 v[212:213], v4 offset:63808
    ds_read_b64_tr_b16 v[214:215], v4 offset:64320
    v_exp_f32 v58, v58
    v_mul_f32 v59, s60, v59
    v_cvt_pk_bf16_f32 v24, v56, v57
    v_mfma_f32_32x32x16_bf16 v[32:47], v[184:187], v[152:155], v[32:47]
    ds_read_b64_tr_b16 v[216:217], v4 offset:63872
    ds_read_b64_tr_b16 v[218:219], v4 offset:64384
    v_exp_f32 v59, v59
    v_mul_f32 v60, s60, v60
    v_mfma_f32_32x32x16_bf16 v[32:47], v[188:191], v[156:159], v[32:47]
    ds_read_b64_tr_b16 v[220:221], v4 offset:63936
    ds_read_b64_tr_b16 v[222:223], v4 offset:64448
    v_exp_f32 v60, v60
    v_mul_f32 v61, s60, v61
    v_cvt_pk_bf16_f32 v25, v58, v59
    s_waitcnt lgkmcnt(8)
    v_mfma_f32_32x32x16_bf16 v[64:79], v[192:195], v[20:23], v[64:79]
    v_exp_f32 v61, v61
    v_mul_f32 v62, s60, v62
    v_mfma_f32_32x32x16_bf16 v[80:95], v[196:199], v[20:23], v[80:95]
    v_exp_f32 v62, v62
    v_mul_f32 v63, s60, v63
    v_cvt_pk_bf16_f32 v26, v60, v61
    v_mfma_f32_32x32x16_bf16 v[96:111], v[200:203], v[20:23], v[96:111]
    v_exp_f32 v63, v63
    v_mul_f32 v32, s60, v32
    v_mul_f32 v33, s60, v33
    v_mfma_f32_32x32x16_bf16 v[112:127], v[204:207], v[20:23], v[112:127]
    s_waitcnt lgkmcnt(0)
    s_barrier
    v_exp_f32 v32, v32
    v_cvt_pk_bf16_f32 v27, v62, v63
    v_mfma_f32_16x16x32_bf16 v[12:15], v[16:19], v[20:23], v[12:15]
    ds_read_b128 v[160:163], v3 offset:17024
    ds_read_b128 v[164:167], v3 offset:17040
    v_mfma_f32_32x32x16_bf16 v[64:79], v[208:211], v[24:27], v[64:79]
    ds_read_b128 v[168:171], v3 offset:17056
    ds_read_b128 v[172:175], v3 offset:17072
    v_exp_f32 v33, v33
    v_mul_f32 v34, s60, v34
    v_mfma_f32_32x32x16_bf16 v[80:95], v[212:215], v[24:27], v[80:95]
    ds_read_b128 v[176:179], v3 offset:17088
    ds_read_b128 v[180:183], v3 offset:17104
    v_exp_f32 v34, v34
    v_mul_f32 v35, s60, v35
    v_cvt_pk_bf16_f32 v20, v32, v33
    v_mfma_f32_32x32x16_bf16 v[96:111], v[216:219], v[24:27], v[96:111]
    ds_read_b128 v[184:187], v3 offset:17120
    v_exp_f32 v35, v35
    v_mul_f32 v36, s60, v36
    v_mfma_f32_32x32x16_bf16 v[112:127], v[220:223], v[24:27], v[112:127]
    ds_read_b128 v[188:191], v3 offset:17136
    v_exp_f32 v36, v36
    v_mul_f32 v37, s60, v37
    v_cvt_pk_bf16_f32 v21, v34, v35
    v_mfma_f32_16x16x32_bf16 v[12:15], v[16:19], v[24:27], v[12:15]
L_b8:
    s_waitcnt lgkmcnt(4)
    v_mfma_f32_32x32x16_bf16 v[48:63], v[160:163], v[128:131], 0
    ds_read_b64_tr_b16 v[192:193], v4 offset:8320
    ds_read_b64_tr_b16 v[194:195], v4 offset:8832
    v_exp_f32 v37, v37
    v_mul_f32 v38, s60, v38
    v_mfma_f32_32x32x16_bf16 v[48:63], v[164:167], v[132:135], v[48:63]
    ds_read_b64_tr_b16 v[196:197], v4 offset:8384
    ds_read_b64_tr_b16 v[198:199], v4 offset:8896
    v_exp_f32 v38, v38
    v_mul_f32 v39, s60, v39
    v_cvt_pk_bf16_f32 v22, v36, v37
    v_mfma_f32_32x32x16_bf16 v[48:63], v[168:171], v[136:139], v[48:63]
    ds_read_b64_tr_b16 v[200:201], v4 offset:8448
    ds_read_b64_tr_b16 v[202:203], v4 offset:8960
    v_exp_f32 v39, v39
    v_mul_f32 v40, s60, v40
    v_mfma_f32_32x32x16_bf16 v[48:63], v[172:175], v[140:143], v[48:63]
    ds_read_b64_tr_b16 v[204:205], v4 offset:8512
    ds_read_b64_tr_b16 v[206:207], v4 offset:9024
    v_exp_f32 v40, v40
    v_mul_f32 v41, s60, v41
    v_cvt_pk_bf16_f32 v23, v38, v39
    s_waitcnt lgkmcnt(8)
    v_mfma_f32_32x32x16_bf16 v[48:63], v[176:179], v[144:147], v[48:63]
    ds_read_b64_tr_b16 v[208:209], v4 offset:12672
    ds_read_b64_tr_b16 v[210:211], v4 offset:13184
    v_exp_f32 v41, v41
    v_mul_f32 v42, s60, v42
    v_mfma_f32_32x32x16_bf16 v[48:63], v[180:183], v[148:151], v[48:63]
    ds_read_b64_tr_b16 v[212:213], v4 offset:12736
    ds_read_b64_tr_b16 v[214:215], v4 offset:13248
    v_exp_f32 v42, v42
    v_mul_f32 v43, s60, v43
    v_cvt_pk_bf16_f32 v24, v40, v41
    v_mfma_f32_32x32x16_bf16 v[48:63], v[184:187], v[152:155], v[48:63]
    ds_read_b64_tr_b16 v[216:217], v4 offset:12800
    ds_read_b64_tr_b16 v[218:219], v4 offset:13312
    v_exp_f32 v43, v43
    v_mul_f32 v44, s60, v44
    v_mfma_f32_32x32x16_bf16 v[48:63], v[188:191], v[156:159], v[48:63]
    ds_read_b64_tr_b16 v[220:221], v4 offset:12864
    ds_read_b64_tr_b16 v[222:223], v4 offset:13376
    v_exp_f32 v44, v44
    v_mul_f32 v45, s60, v45
    v_cvt_pk_bf16_f32 v25, v42, v43
    s_waitcnt lgkmcnt(8)
    v_mfma_f32_32x32x16_bf16 v[64:79], v[192:195], v[20:23], v[64:79]
    v_exp_f32 v45, v45
    v_mul_f32 v46, s60, v46
    v_mfma_f32_32x32x16_bf16 v[80:95], v[196:199], v[20:23], v[80:95]
    v_exp_f32 v46, v46
    v_mul_f32 v47, s60, v47
    v_cvt_pk_bf16_f32 v26, v44, v45
L_tP2:
    s_cbranch_execz L_tret
    v_mfma_f32_32x32x16_bf16 v[96:111], v[200:203], v[20:23], v[96:111]
    v_exp_f32 v47, v47
    v_mul_f32 v48, s60, v48
    v_mul_f32 v49, s60, v49
    v_mfma_f32_32x32x16_bf16 v[112:127], v[204:207], v[20:23], v[112:127]
    s_waitcnt lgkmcnt(0)
    s_barrier
    v_exp_f32 v48, v48
    v_cvt_pk_bf16_f32 v27, v46, v47
    v_mfma_f32_16x16x32_bf16 v[12:15], v[16:19], v[20:23], v[12:15]
    ds_read_b128 v[160:163], v3 offset:34048
    ds_read_b128 v[164:167], v3 offset:34064
    v_mfma_f32_32x32x16_bf16 v[64:79], v[208:211], v[24:27], v[64:79]
    ds_read_b128 v[168:171], v3 offset:34080
    ds_read_b128 v[172:175], v3 offset:34096
    v_exp_f32 v49, v49
    v_mul_f32 v50, s60, v50
    v_mfma_f32_32x32x16_bf16 v[80:95], v[212:215], v[24:27], v[80:95]
    ds_read_b128 v[176:179], v3 offset:34112
    ds_read_b128 v[180:183], v3 offset:34128
    v_exp_f32 v50, v50
    v_mul_f32 v51, s60, v51
    v_cvt_pk_bf16_f32 v20, v48, v49
    v_mfma_f32_32x32x16_bf16 v[96:111], v[216:219], v[24:27], v[96:111]
    ds_read_b128 v[184:187], v3 offset:34144
    v_exp_f32 v51, v51
    v_mul_f32 v52, s60, v52
    v_mfma_f32_32x32x16_bf16 v[112:127], v[220:223], v[24:27], v[112:127]
    ds_read_b128 v[188:191], v3 offset:34160
    v_exp_f32 v52, v52
    v_mul_f32 v53, s60, v53
    v_cvt_pk_bf16_f32 v21, v50, v51
    v_mfma_f32_16x16x32_bf16 v[12:15], v[16:19], v[24:27], v[12:15]
L_b9:
    s_waitcnt lgkmcnt(4)
    v_mfma_f32_32x32x16_bf16 v[32:47], v[160:163], v[128:131], 0
    ds_read_b64_tr_b16 v[192:193], v4 offset:25344
    ds_read_b64_tr_b16 v[194:195], v4 offset:25856
    v_exp_f32 v53, v53
    v_mul_f32 v54, s60, v54
    v_mfma_f32_32x32x16_bf16 v[32:47], v[164:167], v[132:135], v[32:47]
    ds_read_b64_tr_b16 v[196:197], v4 offset:25408
    ds_read_b64_tr_b16 v[198:199], v4 offset:25920
    v_exp_f32 v54, v54
    v_mul_f32 v55, s60, v55
    v_cvt_pk_bf16_f32 v22, v52, v53
    v_mfma_f32_32x32x16_bf16 v[32:47], v[168:171], v[136:139], v[32:47]
    ds_read_b64_tr_b16 v[200:201], v4 offset:25472
    ds_read_b64_tr_b16 v[202:203], v4 offset:25984
    v_exp_f32 v55, v55
    v_mul_f32 v56, s60, v56
    v_mfma_f32_32x32x16_bf16 v[32:47], v[172:175], v[140:143], v[32:47]
    ds_read_b64_tr_b16 v[204:205], v4 offset:25536
    ds_read_b64_tr_b16 v[206:207], v4 offset:26048
    v_exp_f32 v56, v56
    v_mul_f32 v57, s60, v57
    v_cvt_pk_bf16_f32 v23, v54, v55
    s_waitcnt lgkmcnt(8)
    v_mfma_f32_32x32x16_bf16 v[32:47], v[176:179], v[144:147], v[32:47]
    ds_read_b64_tr_b16 v[208:209], v4 offset:29696
    ds_read_b64_tr_b16 v[210:211], v4 offset:30208
    v_exp_f32 v57, v57
    v_mul_f32 v58, s60, v58
    v_mfma_f32_32x32x16_bf16 v[32:47], v[180:183], v[148:151], v[32:47]
    ds_read_b64_tr_b16 v[212:213], v4 offset:29760
    ds_read_b64_tr_b16 v[214:215], v4 offset:30272
    v_exp_f32 v58, v58
    v_mul_f32 v59, s60, v59
    v_cvt_pk_bf16_f32 v24, v56, v57
    v_mfma_f32_32x32x16_bf16 v[32:47], v[184:187], v[152:155], v[32:47]
    ds_read_b64_tr_b16 v[216:217], v4 offset:29824
    ds_read_b64_tr_b16 v[218:219], v4 offset:30336
    v_exp_f32 v59, v59
    v_mul_f32 v60, s60, v60
    v_mfma_f32_32x32x16_bf16 v[32:47], v[188:191], v[156:159], v[32:47]
    ds_read_b64_tr_b16 v[220:221], v4 offset:29888
    ds_read_b64_tr_b16 v[222:223], v4 offset:30400
    v_exp_f32 v60, v60
    v_mul_f32 v61, s60, v61
    v_cvt_pk_bf16_f32 v25, v58, v59
    s_waitcnt lgkmcnt(8)
    v_mfma_f32_32x32x16_bf16 v[64:79], v[192:195], v[20:23], v[64:79]
    v_exp_f32 v61, v61
    v_mul_f32 v62, s60, v62
    v_mfma_f32_32x32x16_bf16 v[80:95], v[196:199], v[20:23], v[80:95]
    v_exp_f32 v62, v62
    v_mul_f32 v63, s60, v63
    v_cvt_pk_bf16_f32 v26, v60, v61
    v_mfma_f32_32x32x16_bf16 v[96:111], v[200:203], v[20:23], v[96:111]
    v_exp_f32 v63, v63
    v_mul_f32 v32, s60, v32
    v_mul_f32 v33, s60, v33
    v_mfma_f32_32x32x16_bf16 v[112:127], v[204:207], v[20:23], v[112:127]
    s_waitcnt lgkmcnt(0)
    s_barrier
    ds_read_b64_tr_b16 v[192:193], v4 offset:42368
    ds_read_b64_tr_b16 v[194:195], v4 offset:42880
    v_exp_f32 v32, v32
    v_cvt_pk_bf16_f32 v27, v62, v63
    v_mfma_f32_16x16x32_bf16 v[12:15], v[16:19], v[20:23], v[12:15]
    ds_read_b64_tr_b16 v[196:197], v4 offset:42432
    ds_read_b64_tr_b16 v[198:199], v4 offset:42944
    v_mfma_f32_32x32x16_bf16 v[64:79], v[208:211], v[24:27], v[64:79]
    ds_read_b64_tr_b16 v[200:201], v4 offset:42496
    ds_read_b64_tr_b16 v[202:203], v4 offset:43008
    v_exp_f32 v33, v33
    v_mul_f32 v34, s60, v34
    v_mul_f32 v35, s60, v35
    v_exp_f32 v34, v34
    v_mfma_f32_32x32x16_bf16 v[80:95], v[212:215], v[24:27], v[80:95]
    ds_read_b64_tr_b16 v[204:205], v4 offset:42560
    ds_read_b64_tr_b16 v[206:207], v4 offset:43072
    v_exp_f32 v35, v35
    v_mul_f32 v36, s60, v36
    v_mul_f32 v37, s60, v37
    v_exp_f32 v36, v36
    v_cvt_pk_bf16_f32 v20, v32, v33
    v_mfma_f32_32x32x16_bf16 v[96:111], v[216:219], v[24:27], v[96:111]
    v_exp_f32 v37, v37
    v_mul_f32 v38, s60, v38
    v_mul_f32 v39, s60, v39
    v_exp_f32 v38, v38
    v_cvt_pk_bf16_f32 v21, v34, v35
    v_mfma_f32_32x32x16_bf16 v[112:127], v[220:223], v[24:27], v[112:127]
    v_exp_f32 v39, v39
    v_cvt_pk_bf16_f32 v22, v36, v37
    v_mul_f32 v40, s60, v40
    v_cvt_pk_bf16_f32 v23, v38, v39
    v_mul_f32 v41, s60, v41
    v_mfma_f32_16x16x32_bf16 v[12:15], v[16:19], v[24:27], v[12:15]
L_b10:
    s_waitcnt lgkmcnt(0)
    v_mfma_f32_32x32x16_bf16 v[64:79], v[192:195], v[20:23], v[64:79]
    ds_read_b64_tr_b16 v[208:209], v4 offset:46720
    ds_read_b64_tr_b16 v[210:211], v4 offset:47232
    ds_read_b64_tr_b16 v[212:213], v4 offset:46784
    v_exp_f32 v40, v40
    v_mul_f32 v42, s60, v42
    v_exp_f32 v41, v41
    v_mul_f32 v43, s60, v43
    v_mfma_f32_32x32x16_bf16 v[80:95], v[196:199], v[20:23], v[80:95]
    ds_read_b64_tr_b16 v[214:215], v4 offset:47296
    ds_read_b64_tr_b16 v[216:217], v4 offset:46848
    ds_read_b64_tr_b16 v[218:219], v4 offset:47360
    v_exp_f32 v42, v42
    v_mul_f32 v44, s60, v44
    v_exp_f32 v43, v43
    v_mul_f32 v45, s60, v45
    v_mfma_f32_32x32x16_bf16 v[96:111], v[200:203], v[20:23], v[96:111]
    ds_read_b64_tr_b16 v[220:221], v4 offset:46912
    ds_read_b64_tr_b16 v[222:223], v4 offset:47424
    v_exp_f32 v44, v44
    v_mul_f32 v46, s60, v46
    v_exp_f32 v45, v45
    v_mul_f32 v47, s60, v47
    v_mfma_f32_32x32x16_bf16 v[112:127], v[204:207], v[20:23], v[112:127]
    v_exp_f32 v46, v46
    v_cvt_pk_bf16_f32 v24, v40, v41
    v_exp_f32 v47, v47
    v_cvt_pk_bf16_f32 v25, v42, v43
    s_cmp_eq_u32 s21, 0
    v_mfma_f32_16x16x32_bf16 v[12:15], v[16:19], v[20:23], v[12:15]
    v_cvt_pk_bf16_f32 v26, v44, v45
    v_cvt_pk_bf16_f32 v27, v46, v47
    s_cbranch_scc0 L_tailS
    s_waitcnt lgkmcnt(0)
    s_nop 0
L_done:
    v_mfma_f32_16x16x32_bf16 v[12:15], v[16:19], v[24:27], v[12:15]
    v_mfma_f32_32x32x16_bf16 v[64:79], v[208:211], v[24:27], v[64:79]
    s_nop 5
    v_mfma_f32_32x32x16_bf16 v[80:95], v[212:215], v[24:27], v[80:95]
    v_subrev_f32 v12, s20, v12
    v_cmp_lt_f32 vcc, 0x3c800000, v12
    v_cmp_gt_f32 s[82:83], v228, v12
    s_and_b64 vcc, vcc, s[82:83]
    s_cmp_eq_u64 vcc, -1
    s_cbranch_scc0 L_fallback
    v_mfma_f32_32x32x16_bf16 v[96:111], v[216:219], v[24:27], v[96:111]
    v_rcp_f32 v28, v12
    v_mfma_f32_32x32x16_bf16 v[112:127], v[220:223], v[24:27], v[112:127]
L_fN:
    v_pk_mul_f32 v[64:65], v[64:65], v[28:29] op_sel_hi:[1,0]
    v_pk_mul_f32 v[66:67], v[66:67], v[28:29] op_sel_hi:[1,0]
    v_pk_mul_f32 v[68:69], v[68:69], v[28:29] op_sel_hi:[1,0]
    v_pk_mul_f32 v[70:71], v[70:71], v[28:29] op_sel_hi:[1,0]
    v_cvt_pk_bf16_f32 v192, v64, v65
    v_cvt_pk_bf16_f32 v193, v66, v67
    v_cvt_pk_bf16_f32 v194, v68, v69
    v_cvt_pk_bf16_f32 v195, v70, v71
    ds_write_b128 v6, v[192:195] offset:0
    v_pk_mul_f32 v[72:73], v[72:73], v[28:29] op_sel_hi:[1,0]
    v_pk_mul_f32 v[74:75], v[74:75], v[28:29] op_sel_hi:[1,0]
    v_pk_mul_f32 v[76:77], v[76:77], v[28:29] op_sel_hi:[1,0]
    v_pk_mul_f32 v[78:79], v[78:79], v[28:29] op_sel_hi:[1,0]
    v_cvt_pk_bf16_f32 v196, v72, v73
    v_cvt_pk_bf16_f32 v197, v74, v75
    v_cvt_pk_bf16_f32 v198, v76, v77
    v_cvt_pk_bf16_f32 v199, v78, v79
    ds_write_b128 v7, v[196:199] offset:0
    v_pk_mul_f32 v[80:81], v[80:81], v[28:29] op_sel_hi:[1,0]
    v_pk_mul_f32 v[82:83], v[82:83], v[28:29] op_sel_hi:[1,0]
    v_pk_mul_f32 v[84:85], v[84:85], v[28:29] op_sel_hi:[1,0]
    v_pk_mul_f32 v[86:87], v[86:87], v[28:29] op_sel_hi:[1,0]
    v_cvt_pk_bf16_f32 v200, v80, v81
    v_cvt_pk_bf16_f32 v201, v82, v83
    v_cvt_pk_bf16_f32 v202, v84, v85
    v_cvt_pk_bf16_f32 v203, v86, v87
    ds_write_b128 v8, v[200:203] offset:0
    v_pk_mul_f32 v[88:89], v[88:89], v[28:29] op_sel_hi:[1,0]
    v_pk_mul_f32 v[90:91], v[90:91], v[28:29] op_sel_hi:[1,0]
    v_pk_mul_f32 v[92:93], v[92:93], v[28:29] op_sel_hi:[1,0]
    v_pk_mul_f32 v[94:95], v[94:95], v[28:29] op_sel_hi:[1,0]
    v_cvt_pk_bf16_f32 v204, v88, v89
    v_cvt_pk_bf16_f32 v205, v90, v91
    v_cvt_pk_bf16_f32 v206, v92, v93
    v_cvt_pk_bf16_f32 v207, v94, v95
    ds_write_b128 v9, v[204:207] offset:0
    ds_read_b128 v[160:163], v10 offset:0
    ds_read_b128 v[164:167], v10 offset:1024
    ds_read_b128 v[168:171], v10 offset:2048
    ds_read_b128 v[172:175], v10 offset:3072
    v_pk_mul_f32 v[96:97], v[96:97], v[28:29] op_sel_hi:[1,0]
    v_pk_mul_f32 v[98:99], v[98:99], v[28:29] op_sel_hi:[1,0]
    v_pk_mul_f32 v[100:101], v[100:101], v[28:29] op_sel_hi:[1,0]
    v_pk_mul_f32 v[102:103], v[102:103], v[28:29] op_sel_hi:[1,0]
    v_cvt_pk_bf16_f32 v208, v96, v97
    v_cvt_pk_bf16_f32 v209, v98, v99
    v_cvt_pk_bf16_f32 v210, v100, v101
    v_cvt_pk_bf16_f32 v211, v102, v103
    ds_write_b128 v6, v[208:211] offset:4096
    v_pk_mul_f32 v[104:105], v[104:105], v[28:29] op_sel_hi:[1,0]
    v_pk_mul_f32 v[106:107], v[106:107], v[28:29] op_sel_hi:[1,0]
    v_pk_mul_f32 v[108:109], v[108:109], v[28:29] op_sel_hi:[1,0]
    v_pk_mul_f32 v[110:111], v[110:111], v[28:29] op_sel_hi:[1,0]
    v_cvt_pk_bf16_f32 v212, v104, v105
    v_cvt_pk_bf16_f32 v213, v106, v107
    v_cvt_pk_bf16_f32 v214, v108, v109
    v_cvt_pk_bf16_f32 v215, v110, v111
    ds_write_b128 v7, v[212:215] offset:4096
    s_waitcnt lgkmcnt(5)
    buffer_store_dwordx4 v[160:163], v11, s[48:51], s84 offen offset:0 sc1
    s_waitcnt lgkmcnt(4)
    buffer_store_dwordx4 v[164:167], v11, s[48:51], s85 offen offset:0 sc1
    s_waitcnt lgkmcnt(3)
    buffer_store_dwordx4 v[168:171], v11, s[48:51], s86 offen offset:0 sc1
    s_waitcnt lgkmcnt(2)
    buffer_store_dwordx4 v[172:175], v11, s[48:51], s87 offen offset:0 sc1
    v_pk_mul_f32 v[112:113], v[112:113], v[28:29] op_sel_hi:[1,0]
    v_pk_mul_f32 v[114:115], v[114:115], v[28:29] op_sel_hi:[1,0]
    v_pk_mul_f32 v[116:117], v[116:117], v[28:29] op_sel_hi:[1,0]
    v_pk_mul_f32 v[118:119], v[118:119], v[28:29] op_sel_hi:[1,0]
    v_cvt_pk_bf16_f32 v216, v112, v113
    v_cvt_pk_bf16_f32 v217, v114, v115
    v_cvt_pk_bf16_f32 v218, v116, v117
    v_cvt_pk_bf16_f32 v219, v118, v119
    ds_write_b128 v8, v[216:219] offset:4096
    v_pk_mul_f32 v[120:121], v[120:121], v[28:29] op_sel_hi:[1,0]
    v_pk_mul_f32 v[122:123], v[122:123], v[28:29] op_sel_hi:[1,0]
    v_pk_mul_f32 v[124:125], v[124:125], v[28:29] op_sel_hi:[1,0]
    v_pk_mul_f32 v[126:127], v[126:127], v[28:29] op_sel_hi:[1,0]
    v_cvt_pk_bf16_f32 v220, v120, v121
    v_cvt_pk_bf16_f32 v221, v122, v123
    v_cvt_pk_bf16_f32 v222, v124, v125
    v_cvt_pk_bf16_f32 v223, v126, v127
    ds_write_b128 v9, v[220:223] offset:4096
    ds_read_b128 v[176:179], v10 offset:4096
    ds_read_b128 v[180:183], v10 offset:5120
    ds_read_b128 v[184:187], v10 offset:6144
    ds_read_b128 v[188:191], v10 offset:7168
    s_waitcnt lgkmcnt(3)
    buffer_store_dwordx4 v[176:179], v11, s[48:51], s84 offen offset:128 sc1
    s_waitcnt lgkmcnt(2)
    buffer_store_dwordx4 v[180:183], v11, s[48:51], s85 offen offset:128 sc1
    s_waitcnt lgkmcnt(1)
    buffer_store_dwordx4 v[184:187], v11, s[48:51], s86 offen offset:128 sc1
    s_waitcnt lgkmcnt(0)
    buffer_store_dwordx4 v[188:191], v11, s[48:51], s87 offen offset:128 sc1
    s_endpgm
.p2align 6
L_tS:
    s_branch L_tret
L_tailS:
    s_waitcnt lgkmcnt(0)
    v_mfma_f32_16x16x32_bf16 v[12:15], v[16:19], v[24:27], v[12:15]
    v_mfma_f32_32x32x16_bf16 v[96:111], v[216:219], v[24:27], v[96:111]
    v_add_u32 v28, s22, v5
    v_lshrrev_b32 v30, 2, v5
    v_add_u32 v29, s23, v5
    v_add_u32 v31, s30, v30
    v_add_u32 v30, s29, v30
    s_mov_b32 m0, s22
    v_mfma_f32_32x32x16_bf16 v[112:127], v[220:223], v[24:27], v[112:127]
    ds_write_b32 v30, v12
    s_nop 4
    v_mfma_f32_32x32x16_bf16 v[64:79], v[208:211], v[24:27], v[64:79]
    ds_write_b128 v28, v[96:99] offset:0
    ds_write_b128 v28, v[100:103] offset:1024
    ds_write_b128 v28, v[104:107] offset:2048
    ds_write_b128 v28, v[108:111] offset:3072
    v_mfma_f32_32x32x16_bf16 v[80:95], v[212:215], v[24:27], v[80:95]
    ds_write_b128 v28, v[112:115] offset:4096
    ds_write_b128 v28, v[116:119] offset:5120
    ds_write_b128 v28, v[120:123] offset:6144
    ds_write_b128 v28, v[124:127] offset:7168
    s_waitcnt lgkmcnt(0)
    s_barrier
    ds_read_b32 v31, v31
    ds_read_b128 v[160:163], v29 offset:0
    ds_read_b128 v[164:167], v29 offset:1024
    ds_read_b128 v[168:171], v29 offset:2048
    ds_read_b128 v[172:175], v29 offset:3072
    ds_read_b128 v[176:179], v29 offset:4096
    ds_read_b128 v[180:183], v29 offset:5120
    ds_read_b128 v[184:187], v29 offset:6144
    ds_read_b128 v[188:191], v29 offset:7168
    s_waitcnt lgkmcnt(8)
    v_add_f32 v12, v12, v31
    v_subrev_f32 v12, s20, v12
    v_cmp_lt_f32 vcc, 0x3c800000, v12
    v_cmp_gt_f32 s[82:83], v228, v12
    s_and_b64 vcc, vcc, s[82:83]
    s_cmp_eq_u64 vcc, -1
    s_cbranch_scc0 L_fallback
    v_rcp_f32 v28, v12
L_fS:
    s_waitcnt lgkmcnt(7)
    v_pk_add_f32 v[64:65], v[64:65], v[160:161]
    v_pk_add_f32 v[66:67], v[66:67], v[162:163]
    v_pk_mul_f32 v[64:65], v[64:65], v[28:29] op_sel_hi:[1,0]
    v_pk_mul_f32 v[66:67], v[66:67], v[28:29] op_sel_hi:[1,0]
    s_waitcnt lgkmcnt(6)
    v_pk_add_f32 v[68:69], v[68:69], v[164:165]
    v_pk_add_f32 v[70:71], v[70:71], v[166:167]
    v_pk_mul_f32 v[68:69], v[68:69], v[28:29] op_sel_hi:[1,0]
    v_pk_mul_f32 v[70:71], v[70:71], v[28:29] op_sel_hi:[1,0]
    v_cvt_pk_bf16_f32 v192, v64, v65
    v_cvt_pk_bf16_f32 v193, v66, v67
    v_cvt_pk_bf16_f32 v194, v68, v69
    v_cvt_pk_bf16_f32 v195, v70, v71
    ds_write_b128 v6, v[192:195] offset:0
    s_waitcnt lgkmcnt(6)
    v_pk_add_f32 v[72:73], v[72:73], v[168:169]
    v_pk_add_f32 v[74:75], v[74:75], v[170:171]
    v_pk_mul_f32 v[72:73], v[72:73], v[28:29] op_sel_hi:[1,0]
    v_pk_mul_f32 v[74:75], v[74:75], v[28:29] op_sel_hi:[1,0]
    s_waitcnt lgkmcnt(5)
    v_pk_add_f32 v[76:77], v[76:77], v[172:173]
    v_pk_add_f32 v[78:79], v[78:79], v[174:175]
    v_pk_mul_f32 v[76:77], v[76:77], v[28:29] op_sel_hi:[1,0]
    v_pk_mul_f32 v[78:79], v[78:79], v[28:29] op_sel_hi:[1,0]
    v_cvt_pk_bf16_f32 v196, v72, v73
    v_cvt_pk_bf16_f32 v197, v74, v75
    v_cvt_pk_bf16_f32 v198, v76, v77
    v_cvt_pk_bf16_f32 v199, v78, v79
    ds_write_b128 v7, v[196:199] offset:0
    s_waitcnt lgkmcnt(5)
    v_pk_add_f32 v[80:81], v[80:81], v[176:177]
    v_pk_add_f32 v[82:83], v[82:83], v[178:179]
    v_pk_mul_f32 v[80:81], v[80:81], v[28:29] op_sel_hi:[1,0]
    v_pk_mul_f32 v[82:83], v[82:83], v[28:29] op_sel_hi:[1,0]
    s_waitcnt lgkmcnt(4)
    v_pk_add_f32 v[84:85], v[84:85], v[180:181]
    v_pk_add_f32 v[86:87], v[86:87], v[182:183]
    v_pk_mul_f32 v[84:85], v[84:85], v[28:29] op_sel_hi:[1,0]
    v_pk_mul_f32 v[86:87], v[86:87], v[28:29] op_sel_hi:[1,0]
    v_cvt_pk_bf16_f32 v200, v80, v81
    v_cvt_pk_bf16_f32 v201, v82, v83
    v_cvt_pk_bf16_f32 v202, v84, v85
    v_cvt_pk_bf16_f32 v203, v86, v87
    ds_write_b128 v8, v[200:203] offset:0
    s_waitcnt lgkmcnt(4)
    v_pk_add_f32 v[88:89], v[88:89], v[184:185]
    v_pk_add_f32 v[90:91], v[90:91], v[186:187]
    v_pk_mul_f32 v[88:89], v[88:89], v[28:29] op_sel_hi:[1,0]
    v_pk_mul_f32 v[90:91], v[90:91], v[28:29] op_sel_hi:[1,0]
    s_waitcnt lgkmcnt(3)
    v_pk_add_f32 v[92:93], v[92:93], v[188:189]
    v_pk_add_f32 v[94:95], v[94:95], v[190:191]
    v_pk_mul_f32 v[92:93], v[92:93], v[28:29] op_sel_hi:[1,0]
    v_pk_mul_f32 v[94:95], v[94:95], v[28:29] op_sel_hi:[1,0]
    v_cvt_pk_bf16_f32 v204, v88, v89
    v_cvt_pk_bf16_f32 v205, v90, v91
    v_cvt_pk_bf16_f32 v206, v92, v93
    v_cvt_pk_bf16_f32 v207, v94, v95
    ds_write_b128 v9, v[204:207] offset:0
    ds_read_b128 v[208:211], v10 offset:0
    ds_read_b128 v[212:215], v10 offset:1024
    ds_read_b128 v[216:219], v10 offset:2048
    ds_read_b128 v[220:223], v10 offset:3072
    s_waitcnt lgkmcnt(3)
    buffer_store_dwordx4 v[208:211], v11, s[48:51], s84 offen offset:0 sc1
    s_waitcnt lgkmcnt(2)
    buffer_store_dwordx4 v[212:215], v11, s[48:51], s85 offen offset:0 sc1
    s_waitcnt lgkmcnt(1)
    buffer_store_dwordx4 v[216:219], v11, s[48:51], s86 offen offset:0 sc1
    s_waitcnt lgkmcnt(0)
    buffer_store_dwordx4 v[220:223], v11, s[48:51], s87 offen offset:0 sc1
    s_endpgm
.p2align 7
L_table:
    .long 0x10, 0x0, 0xa4280, 0x16c780, 0x24280, 0x463c0, 0xec780, 0xc010e8c0, 0x463c0, 0x60000, 0x10e8c0, 0x80128500, 0x60000, 0x82140, 0x128500, 0x8014a640, 0x82140, 0xa4280, 0x14a640, 0x8016c780, 0x0, 0x0, 0x0, 0x0, 0x0, 0x0, 0x0, 0x0, 0x0, 0x0, 0x0, 0x170100
    .long 0x0, 0x1f100, 0x23480, 0x6, 0x41700000, 0x1, 0x0, 0x8500, 0x0, 0x0, 0x170100, 0x40171, 0x2080, 0x27600, 0x27800, 0x4280
    .long 0x20000, 0x1f100, 0x25500, 0x6, 0x41700000, 0x1, 0x4280, 0xc780, 0x0, 0x0, 0x170100, 0x40171, 0x6300, 0x27700, 0x27900, 0x4280
    .long 0x80, 0x1f080, 0x23480, 0x6, 0x41700000, 0x2, 0x8500, 0x0, 0x10a00, 0x0, 0x170100, 0x100171, 0xe800, 0x27800, 0x27600, 0x14c80
    .long 0x20080, 0x1f080, 0x25500, 0x6, 0x41700000, 0x2, 0xc780, 0x4280, 0x10a00, 0x0, 0x170100, 0x100171, 0x12a80, 0x27900, 0x27700, 0x14c80
    .long 0x10, 0x0, 0x44280, 0x10c780, 0x84280, 0xa63c0, 0x14c780, 0xc016e8c0, 0xa63c0, 0x0, 0x16e8c0, 0x800c8500, 0x0, 0x22140, 0xc8500, 0x800ea640, 0x22140, 0x44280, 0xea640, 0x8010c780, 0x0, 0x0, 0x0, 0x0, 0x0, 0x0, 0x0, 0x0, 0x0, 0x0, 0x0, 0x170100
    .long 0x40000, 0x1f100, 0x23480, 0x6, 0x41700000, 0x1, 0x0, 0x8500, 0x0, 0x0, 0x170100, 0xa0171, 0x2080, 0x27600, 0x27800, 0x4280
    .long 0x60000, 0x1f100, 0x25500, 0x6, 0x41700000, 0x1, 0x4280, 0xc780, 0x0, 0x0, 0x170100, 0xa0171, 0x6300, 0x27700, 0x27900, 0x4280
    .long 0x40080, 0x1f080, 0x23480, 0x6, 0x41700000, 0x2, 0x8500, 0x0, 0x10a00, 0x0, 0x170100, 0x160171, 0xe800, 0x27800, 0x27600, 0x14c80
    .long 0x60080, 0x1f080, 0x25500, 0x6, 0x41700000, 0x2, 0xc780, 0x4280, 0x10a00, 0x0, 0x170100, 0x160171, 0x12a80, 0x27900, 0x27700, 0x14c80
    .long 0x10, 0x0, 0xa4280, 0x16c780, 0x24280, 0x463c0, 0xec780, 0xc010e8c0, 0x463c0, 0x60000, 0x10e8c0, 0x80128500, 0x60000, 0x82140, 0x128500, 0x8014a640, 0x82140, 0xa4280, 0x14a640, 0x8016c780, 0x0, 0x0, 0x0, 0x0, 0x0, 0x0, 0x0, 0x0, 0x0, 0x0, 0x0, 0x170100
    .long 0x80000, 0x1f100, 0x23480, 0x6, 0x41700000, 0x1, 0x0, 0x8500, 0x0, 0x0, 0x170100, 0x40171, 0x2080, 0x27600, 0x27800, 0x4280
    .long 0xa0000, 0x1f100, 0x25500, 0x6, 0x41700000, 0x1, 0x4280, 0xc780, 0x0, 0x0, 0x170100, 0x40171, 0x6300, 0x27700, 0x27900, 0x4280
    .long 0x80080, 0x1f080, 0x23480, 0x6, 0x41700000, 0x2, 0x8500, 0x0, 0x10a00, 0x0, 0x170100, 0x100171, 0xe800, 0x27800, 0x27600, 0x14c80
    .long 0xa0080, 0x1f080, 0x25500, 0x6, 0x41700000, 0x2, 0xc780, 0x4280, 0x10a00, 0x0, 0x170100, 0x100171, 0x12a80, 0x27900, 0x27700, 0x14c80
    .long 0x10, 0x0, 0x44280, 0x10c780, 0x84280, 0xa63c0, 0x14c780, 0xc016e8c0, 0xa63c0, 0x0, 0x16e8c0, 0x800c8500, 0x0, 0x22140, 0xc8500, 0x800ea640, 0x22140, 0x44280, 0xea640, 0x8010c780, 0x0, 0x0, 0x0, 0x0, 0x0, 0x0, 0x0, 0x0, 0x0, 0x0, 0x0, 0x170100
    .long 0xc0000, 0x1f100, 0x23480, 0x6, 0x41700000, 0x1, 0x0, 0x8500, 0x0, 0x0, 0x170100, 0xa0171, 0x2080, 0x27600, 0x27800, 0x4280
    .long 0xe0000, 0x1f100, 0x25500, 0x6, 0x41700000, 0x1, 0x4280, 0xc780, 0x0, 0x0, 0x170100, 0xa0171, 0x6300, 0x27700, 0x27900, 0x4280
    .long 0xc0080, 0x1f080, 0x23480, 0x6, 0x41700000, 0x2, 0x8500, 0x0, 0x10a00, 0x0, 0x170100, 0x160171, 0xe800, 0x27800, 0x27600, 0x14c80
    .long 0xe0080, 0x1f080, 0x25500, 0x6, 0x41700000, 0x2, 0xc780, 0x4280, 0x10a00, 0x0, 0x170100, 0x160171, 0x12a80, 0x27900, 0x27700, 0x14c80
    .long 0x10, 0x0, 0xa4280, 0x16c780, 0x24280, 0x463c0, 0xec780, 0xc010e8c0, 0x463c0, 0x60000, 0x10e8c0, 0x80128500, 0x60000, 0x82140, 0x128500, 0x8014a640, 0x82140, 0xa4280, 0x14a640, 0x8016c780, 0x0, 0x0, 0x0, 0x0, 0x0, 0x0, 0x0, 0x0, 0x0, 0x0, 0x0, 0x170100
    .long 0x100000, 0x1f100, 0x23480, 0x6, 0x41700000, 0x1, 0x0, 0x8500, 0x0, 0x0, 0x170100, 0x40171, 0x2080, 0x27600, 0x27800, 0x4280
    .long 0x120000, 0x1f100, 0x25500, 0x6, 0x41700000, 0x1, 0x4280, 0xc780, 0x0, 0x0, 0x170100, 0x40171, 0x6300, 0x27700, 0x27900, 0x4280
    .long 0x100080, 0x1f080, 0x23480, 0x6, 0x41700000, 0x2, 0x8500, 0x0, 0x10a00, 0x0, 0x170100, 0x100171, 0xe800, 0x27800, 0x27600, 0x14c80
    .long 0x120080, 0x1f080, 0x25500, 0x6, 0x41700000, 0x2, 0xc780, 0x4280, 0x10a00, 0x0, 0x170100, 0x100171, 0x12a80, 0x27900, 0x27700, 0x14c80
    .long 0x10, 0x0, 0x44280, 0x10c780, 0x84280, 0xa63c0, 0x14c780, 0xc016e8c0, 0xa63c0, 0x0, 0x16e8c0, 0x800c8500, 0x0, 0x22140, 0xc8500, 0x800ea640, 0x22140, 0x44280, 0xea640, 0x8010c780, 0x0, 0x0, 0x0, 0x0, 0x0, 0x0, 0x0, 0x0, 0x0, 0x0, 0x0, 0x170100
    .long 0x140000, 0x1f100, 0x23480, 0x6, 0x41700000, 0x1, 0x0, 0x8500, 0x0, 0x0, 0x170100, 0xa0171, 0x2080, 0x27600, 0x27800, 0x4280
    .long 0x160000, 0x10100, 0x25500, 0x6, 0x41700000, 0x1, 0x4280, 0xc780, 0x0, 0x0, 0x170100, 0xa0171, 0x6300, 0x27700, 0x27900, 0x4280
    .long 0x140080, 0x1f080, 0x23480, 0x6, 0x41700000, 0x2, 0x8500, 0x0, 0x10a00, 0x0, 0x170100, 0x160171, 0xe800, 0x27800, 0x27600, 0x14c80
    .long 0x160080, 0x10080, 0x25500, 0x6, 0x41700000, 0x2, 0xc780, 0x4280, 0x10a00, 0x0, 0x170100, 0x160171, 0x12a80, 0x27900, 0x27700, 0x14c80
    .long 0xc, 0x1, 0xc4280, 0x3f8000, 0x0, 0x22140, 0x22140, 0x80044280, 0x44280, 0x800663c0, 0x663c0, 0x80080000, 0x80000, 0x800a2140, 0xa2140, 0x800c4280, 0x0, 0x0, 0x0, 0x0, 0x0, 0x0, 0x0, 0x0, 0x0, 0x0, 0x0, 0x0, 0x0, 0x0, 0x171000, 0xd4100
    .long 0x171000, 0x1f100, 0x1f380, 0x7, 0x41300000, 0x0, 0x0, 0x0, 0x0, 0x171000, 0xd4100, 0x3e00d5, 0x2080, 0x27600, 0x27600, 0x0
    .long 0x191000, 0x1f100, 0x21400, 0x7, 0x41300000, 0x0, 0x4280, 0x4280, 0x0, 0x171000, 0xd4100, 0x3e00d5, 0x6300, 0x27600, 0x27600, 0x0
    .long 0x1b1000, 0x1f100, 0x23480, 0x7, 0x41300000, 0x0, 0x8500, 0x8500, 0x0, 0x171000, 0xd4100, 0x3e00d5, 0xe800, 0x27600, 0x27600, 0x0
    .long 0x1d1000, 0x1f100, 0x25500, 0x7, 0x41300000, 0x0, 0xc780, 0xc780, 0x0, 0x171000, 0xd4100, 0x3e00d5, 0x12a80, 0x27600, 0x27600, 0x0
    .long 0xc, 0x1, 0xa4280, 0x3f8000, 0x0, 0x22140, 0x22140, 0x80044280, 0x44280, 0x800863c0, 0x863c0, 0x800c0000, 0xc0000, 0x80062140, 0x62140, 0x800a4280, 0x0, 0x0, 0x0, 0x0, 0x0, 0x0, 0x0, 0x0, 0x0, 0x0, 0x0, 0x0, 0x0, 0x0, 0x171000, 0xd4100
    .long 0x1f1000, 0x1f100, 0x21400, 0x7, 0x41300000, 0x0, 0x0, 0x0, 0x0, 0x171000, 0xd4100, 0x3e00d5, 0x2080, 0x27600, 0x27600, 0x0
    .long 0x211000, 0x1f100, 0x23480, 0x7, 0x41300000, 0x0, 0x4280, 0x4280, 0x0, 0x171000, 0xd4100, 0x3e00d5, 0x6300, 0x27600, 0x27600, 0x0
    .long 0x231000, 0x14100, 0x25500, 0x7, 0x41300000, 0x0, 0x8500, 0x8500, 0x0, 0x171000, 0xd4100, 0x3e00d5, 0xe800, 0x27600, 0x27600, 0x0
    .long 0x251000, 0x100, 0x27580, 0x0, 0x41300000, 0x0, 0xc780, 0xc780, 0x0, 0x171000, 0xd4100, 0x3e00d5, 0x12a80, 0x27600, 0x27600, 0x0
    .long 0x10, 0x1, 0x104280, 0x3f8000, 0x4280, 0x263c0, 0x263c0, 0x80040000, 0x40000, 0x80062140, 0x62140, 0x800c4280, 0xc4280, 0x800863c0, 0x863c0, 0x800e0000, 0xe0000, 0x800a2140, 0xa2140, 0x80104280, 0x0, 0x0, 0x0, 0x0, 0x0, 0x0, 0x0, 0x0, 0x0, 0x0, 0x246000, 0x11a100
    .long 0x246000, 0x1f100, 0x21400, 0x9, 0x40a00000, 0x0, 0x0, 0x0, 0x0, 0x246000, 0x11a100, 0x3e011b, 0x2080, 0x27600, 0x27600, 0x8500
    .long 0x266000, 0x1f100, 0x23480, 0x9, 0x40a00000, 0x0, 0x4280, 0x4280, 0x0, 0x246000, 0x11a100, 0x3e011b, 0x6300, 0x27600, 0x27600, 0x8500
    .long 0x286000, 0x1f100, 0x25500, 0x9, 0x40a00000, 0x0, 0x8500, 0x8500, 0x0, 0x246000, 0x11a100, 0x3e011b, 0xe800, 0x27600, 0x27600, 0x8500
    .long 0x2a6000, 0x1f100, 0x27580, 0x0, 0x40a00000, 0x0, 0xc780, 0xc780, 0x0, 0x246000, 0x11a100, 0x3e011b, 0x12a80, 0x27600, 0x27600, 0x8500
    .long 0x10, 0x1, 0x64280, 0x3f8000, 0x4280, 0x263c0, 0x263c0, 0x80040000, 0x40000, 0x80082140, 0x82140, 0x800e4280, 0xe4280, 0x800a63c0, 0xa63c0, 0x80100000, 0x100000, 0x800c2140, 0xc2140, 0x80064280, 0x0, 0x0, 0x0, 0x0, 0x0, 0x0, 0x0, 0x0, 0x0, 0x0, 0x246000, 0x11a100
    .long 0x2a6000, 0x1f100, 0x21400, 0x9, 0x40a00000, 0x0, 0x0, 0x0, 0x0, 0x246000, 0x11a100, 0x3e011b, 0x2080, 0x27600, 0x27600, 0x8500
    .long 0x2c6000, 0x1f100, 0x23480, 0x9, 0x40a00000, 0x0, 0x4280, 0x4280, 0x0, 0x246000, 0x11a100, 0x3e011b, 0x6300, 0x27600, 0x27600, 0x8500
    .long 0x2e6000, 0x1f100, 0x25500, 0x9, 0x40a00000, 0x0, 0x8500, 0x8500, 0x0, 0x246000, 0x11a100, 0x3e011b, 0xe800, 0x27600, 0x27600, 0x8500
    .long 0x306000, 0x1f100, 0x27580, 0x0, 0x40a00000, 0x0, 0xc780, 0xc780, 0x0, 0x246000, 0x11a100, 0x3e011b, 0x12a80, 0x27600, 0x27600, 0x8500
    .long 0x10, 0x1, 0xe4280, 0x3f8000, 0x4280, 0x263c0, 0x263c0, 0x80040000, 0x40000, 0x800a2140, 0xa2140, 0x80104280, 0x104280, 0x800c63c0, 0xc63c0, 0x80060000, 0x60000, 0x80082140, 0x82140, 0x800e4280, 0x0, 0x0, 0x0, 0x0, 0x0, 0x0, 0x0, 0x0, 0x0, 0x0, 0x246000, 0x11a100
    .long 0x306000, 0x1f100, 0x21400, 0x9, 0x40a00000, 0x0, 0x0, 0x0, 0x0, 0x246000, 0x11a100, 0x3e011b, 0x2080, 0x27600, 0x27600, 0x8500
    .long 0x326000, 0x1f100, 0x23480, 0x9, 0x40a00000, 0x0, 0x4280, 0x4280, 0x0, 0x246000, 0x11a100, 0x3e011b, 0x6300, 0x27600, 0x27600, 0x8500
    .long 0x346000, 0x1a100, 0x25500, 0x9, 0x40a00000, 0x0, 0x8500, 0x8500, 0x0, 0x246000, 0x11a100, 0x3e011b, 0xe800, 0x27600, 0x27600, 0x8500
    .long 0x366000, 0x100, 0x27580, 0x0, 0x40a00000, 0x0, 0xc780, 0xc780, 0x0, 0x246000, 0x11a100, 0x3e011b, 0x12a80, 0x27600, 0x27600, 0x8500
    .long 0x10, 0x0, 0xa4280, 0x3ec780, 0x24280, 0x463c0, 0xec780, 0xc010e8c0, 0x463c0, 0x60000, 0x10e8c0, 0x80128500, 0x60000, 0x82140, 0x128500, 0x8014a640, 0x82140, 0xa4280, 0x14a640, 0x803ec780, 0x0, 0x0, 0x0, 0x0, 0x0, 0x0, 0x0, 0x0, 0x0, 0x0, 0x361000, 0x14e100
    .long 0x361000, 0x1f100, 0x23480, 0x6, 0x42440000, 0x1, 0x0, 0x8500, 0x0, 0x361000, 0x14e100, 0x4014f, 0x2080, 0x27600, 0x27800, 0x4280
    .long 0x381000, 0x1f100, 0x25500, 0x6, 0x42440000, 0x1, 0x4280, 0xc780, 0x0, 0x361000, 0x14e100, 0x4014f, 0x6300, 0x27700, 0x27900, 0x4280
    .long 0x361080, 0x1f080, 0x23480, 0x6, 0x42440000, 0x2, 0x8500, 0x0, 0x10a00, 0x361000, 0x14e100, 0x10014f, 0xe800, 0x27800, 0x27600, 0x14c80
    .long 0x381080, 0x1f080, 0x25500, 0x6, 0x42440000, 0x2, 0xc780, 0x4280, 0x10a00, 0x361000, 0x14e100, 0x10014f, 0x12a80, 0x27900, 0x27700, 0x14c80
    .long 0x10, 0x0, 0x44280, 0x3ec780, 0x84280, 0xa63c0, 0x14c780, 0xc00ce8c0, 0xa63c0, 0x0, 0xce8c0, 0x800e8500, 0x0, 0x22140, 0xe8500, 0x8010a640, 0x22140, 0x44280, 0x10a640, 0x803ec780, 0x0, 0x0, 0x0, 0x0, 0x0, 0x0, 0x0, 0x0, 0x0, 0x0, 0x361000, 0x14e100
    .long 0x3a1000, 0x1f100, 0x23480, 0x6, 0x42440000, 0x1, 0x0, 0x8500, 0x0, 0x361000, 0x14e100, 0xa014f, 0x2080, 0x27600, 0x27800, 0x4280
    .long 0x3c1000, 0x1f100, 0x25500, 0x6, 0x42440000, 0x1, 0x4280, 0xc780, 0x0, 0x361000, 0x14e100, 0xa014f, 0x6300, 0x27700, 0x27900, 0x4280
    .long 0x3a1080, 0x1f080, 0x23480, 0x6, 0x42440000, 0x2, 0x8500, 0x0, 0x10a00, 0x361000, 0x14e100, 0xc014f, 0xe800, 0x27800, 0x27600, 0x14c80
    .long 0x3c1080, 0x1f080, 0x25500, 0x6, 0x42440000, 0x2, 0xc780, 0x4280, 0x10a00, 0x361000, 0x14e100, 0xc014f, 0x12a80, 0x27900, 0x27700, 0x14c80
    .long 0x10, 0x0, 0xa4280, 0x3ec780, 0x24280, 0x463c0, 0xec780, 0xc010e8c0, 0x463c0, 0x60000, 0x10e8c0, 0x80128500, 0x60000, 0x82140, 0x128500, 0x8014a640, 0x82140, 0xa4280, 0x14a640, 0x803ec780, 0x0, 0x0, 0x0, 0x0, 0x0, 0x0, 0x0, 0x0, 0x0, 0x0, 0x361000, 0x14e100
    .long 0x3e1000, 0x1f100, 0x23480, 0x6, 0x42440000, 0x1, 0x0, 0x8500, 0x0, 0x361000, 0x14e100, 0x4014f, 0x2080, 0x27600, 0x27800, 0x4280
    .long 0x401000, 0x1f100, 0x25500, 0x6, 0x42440000, 0x1, 0x4280, 0xc780, 0x0, 0x361000, 0x14e100, 0x4014f, 0x6300, 0x27700, 0x27900, 0x4280
    .long 0x3e1080, 0x1f080, 0x23480, 0x6, 0x42440000, 0x2, 0x8500, 0x0, 0x10a00, 0x361000, 0x14e100, 0x10014f, 0xe800, 0x27800, 0x27600, 0x14c80
    .long 0x401080, 0x1f080, 0x25500, 0x6, 0x42440000, 0x2, 0xc780, 0x4280, 0x10a00, 0x361000, 0x14e100, 0x10014f, 0x12a80, 0x27900, 0x27700, 0x14c80
    .long 0x10, 0x0, 0x44280, 0x3ec780, 0x84280, 0xa63c0, 0x14c780, 0xc00ce8c0, 0xa63c0, 0x0, 0xce8c0, 0x800e8500, 0x0, 0x22140, 0xe8500, 0x8010a640, 0x22140, 0x44280, 0x10a640, 0x803ec780, 0x0, 0x0, 0x0, 0x0, 0x0, 0x0, 0x0, 0x0, 0x0, 0x0, 0x361000, 0x14e100
    .long 0x421000, 0x1f100, 0x23480, 0x6, 0x42440000, 0x1, 0x0, 0x8500, 0x0, 0x361000, 0x14e100, 0xa014f, 0x2080, 0x27600, 0x27800, 0x4280
    .long 0x441000, 0x1f100, 0x25500, 0x6, 0x42440000, 0x1, 0x4280, 0xc780, 0x0, 0x361000, 0x14e100, 0xa014f, 0x6300, 0x27700, 0x27900, 0x4280
    .long 0x421080, 0x1f080, 0x23480, 0x6, 0x42440000, 0x2, 0x8500, 0x0, 0x10a00, 0x361000, 0x14e100, 0xc014f, 0xe800, 0x27800, 0x27600, 0x14c80
    .long 0x441080, 0x1f080, 0x25500, 0x6, 0x42440000, 0x2, 0xc780, 0x4280, 0x10a00, 0x361000, 0x14e100, 0xc014f, 0x12a80, 0x27900, 0x27700, 0x14c80
    .long 0x14, 0x1, 0x104280, 0x3f8000, 0x0, 0x62140, 0x62140, 0x800c4280, 0xc4280, 0x801263c0, 0x1263c0, 0x80020000, 0x20000, 0x80082140, 0x82140, 0x800e4280, 0xe4280, 0x801463c0, 0x1463c0, 0x80040000, 0x40000, 0x800a2140, 0xa2140, 0x80104280, 0x0, 0x0, 0x0, 0x0, 0x0, 0x0, 0x361000, 0x14e100
    .long 0x461000, 0x1f100, 0x21400, 0xb, 0x41880000, 0x0, 0x0, 0x0, 0x0, 0x361000, 0x14e100, 0x3e014f, 0x2080, 0x27600, 0x27600, 0x0
    .long 0x481000, 0x1f100, 0x23480, 0xb, 0x41880000, 0x0, 0x4280, 0x4280, 0x0, 0x361000, 0x14e100, 0x3e014f, 0x6300, 0x27600, 0x27600, 0x0
    .long 0x4a1000, 0xe100, 0x25500, 0xb, 0x41880000, 0x0, 0x8500, 0x8500, 0x0, 0x361000, 0x14e100, 0x3e014f, 0xe800, 0x27600, 0x27600, 0x0
    .long 0x4c1000, 0x100, 0x27580, 0x0, 0x41880000, 0x0, 0xc780, 0xc780, 0x0, 0x361000, 0x14e100, 0x3e014f, 0x12a80, 0x27600, 0x27600, 0x0
L_tabend:
L_fallback:
    s_waitcnt lgkmcnt(0)
    s_add_u32 s25, s25, s15
    s_add_u32 s52, s6, s25
    s_addc_u32 s53, s7, 0
    s_mov_b32 s54, s26
    s_add_u32 s56, s8, s25
    s_addc_u32 s57, s9, 0
    s_mov_b32 s58, s26
    v_and_b32 v28, 31, v0
    v_lshlrev_b32 v28, 12, v28
    v_lshrrev_b32 v30, 5, v0
    v_lshl_add_u32 v224, v30, 7, v28
    v_lshlrev_b32 v30, 2, v30
    v_lshrrev_b32 v28, 4, v0
    v_lshlrev_b32 v28, 14, v28
    v_and_b32 v29, 15, v0
    v_lshl_add_u32 v225, v29, 4, v28
    s_lshr_b32 s88, s21, 1
    s_lshl_b32 s88, s88, 7
    v_xor_b32 v225, s88, v225
    v_mov_b32 v31, 0xff800000
    v_mov_b32 v226, 0xff800000
    s_sub_u32 s88, s28, 8320
    v_add_u32 v4, s88, v2
    s_mov_b32 s90, 0
L_fb_pass:
    s_mov_b32 s88, 0
    s_and_b32 s89, s27, 0x1ffff
L_fb_tile:
    buffer_load_dwordx4 v[160:163], v224, s[52:55], s88 offen offset:0
    buffer_load_dwordx4 v[164:167], v224, s[52:55], s88 offen offset:16
    buffer_load_dwordx4 v[168:171], v224, s[52:55], s88 offen offset:32
    buffer_load_dwordx4 v[172:175], v224, s[52:55], s88 offen offset:48
    buffer_load_dwordx4 v[176:179], v224, s[52:55], s88 offen offset:64
    buffer_load_dwordx4 v[180:183], v224, s[52:55], s88 offen offset:80
    buffer_load_dwordx4 v[184:187], v224, s[52:55], s88 offen offset:96
    buffer_load_dwordx4 v[188:191], v224, s[52:55], s88 offen offset:112
    v_sub_u32 v29, s89, v30
    v_cmp_ge_i32 vcc, 0, v29
    s_nop 1
    v_cndmask_b32 v48, 0, v31, vcc
    v_cmp_ge_i32 vcc, 1, v29
    s_nop 1
    v_cndmask_b32 v49, 0, v31, vcc
    v_cmp_ge_i32 vcc, 2, v29
    s_nop 1
    v_cndmask_b32 v50, 0, v31, vcc
    v_cmp_ge_i32 vcc, 3, v29
    s_nop 1
    v_cndmask_b32 v51, 0, v31, vcc
    v_cmp_ge_i32 vcc, 8, v29
    s_nop 1
    v_cndmask_b32 v52, 0, v31, vcc
    v_cmp_ge_i32 vcc, 9, v29
    s_nop 1
    v_cndmask_b32 v53, 0, v31, vcc
    v_cmp_ge_i32 vcc, 10, v29
    s_nop 1
    v_cndmask_b32 v54, 0, v31, vcc
    v_cmp_ge_i32 vcc, 11, v29
    s_nop 1
    v_cndmask_b32 v55, 0, v31, vcc
    v_cmp_ge_i32 vcc, 16, v29
    s_nop 1
    v_cndmask_b32 v56, 0, v31, vcc
    v_cmp_ge_i32 vcc, 17, v29
    s_nop 1
    v_cndmask_b32 v57, 0, v31, vcc
    v_cmp_ge_i32 vcc, 18, v29
    s_nop 1
    v_cndmask_b32 v58, 0, v31, vcc
    v_cmp_ge_i32 vcc, 19, v29
    s_nop 1
    v_cndmask_b32 v59, 0, v31, vcc
    v_cmp_ge_i32 vcc, 24, v29
    s_nop 1
    v_cndmask_b32 v60, 0, v31, vcc
    v_cmp_ge_i32 vcc, 25, v29
    s_nop 1
    v_cndmask_b32 v61, 0, v31, vcc
    v_cmp_ge_i32 vcc, 26, v29
    s_nop 1
    v_cndmask_b32 v62, 0, v31, vcc
    v_cmp_ge_i32 vcc, 27, v29
    s_nop 1
    v_cndmask_b32 v63, 0, v31, vcc
    s_waitcnt vmcnt(0)
    v_mfma_f32_32x32x16_bf16 v[32:47], v[160:163], v[128:131], v[48:63]
    v_mfma_f32_32x32x16_bf16 v[32:47], v[164:167], v[132:135], v[32:47]
    v_mfma_f32_32x32x16_bf16 v[32:47], v[168:171], v[136:139], v[32:47]
    v_mfma_f32_32x32x16_bf16 v[32:47], v[172:175], v[140:143], v[32:47]
    v_mfma_f32_32x32x16_bf16 v[32:47], v[176:179], v[144:147], v[32:47]
    v_mfma_f32_32x32x16_bf16 v[32:47], v[180:183], v[148:151], v[32:47]
    v_mfma_f32_32x32x16_bf16 v[32:47], v[184:187], v[152:155], v[32:47]
    v_mfma_f32_32x32x16_bf16 v[32:47], v[188:191], v[156:159], v[32:47]
    s_cmp_eq_u32 s90, 0
    s_cbranch_scc0 L_fb_p2
    s_nop 15
    v_max_f32 v226, v226, v32
    v_max_f32 v226, v226, v33
    v_max_f32 v226, v226, v34
    v_max_f32 v226, v226, v35
    v_max_f32 v226, v226, v36
    v_max_f32 v226, v226, v37
    v_max_f32 v226, v226, v38
    v_max_f32 v226, v226, v39
    v_max_f32 v226, v226, v40
    v_max_f32 v226, v226, v41
    v_max_f32 v226, v226, v42
    v_max_f32 v226, v226, v43
    v_max_f32 v226, v226, v44
    v_max_f32 v226, v226, v45
    v_max_f32 v226, v226, v46
    v_max_f32 v226, v226, v47
    s_branch L_fb_next
L_fb_p2:
    s_add_u32 m0, s28, 0
    s_add_u32 s91, s88, 0
    buffer_load_dwordx4 v225, s[56:59], s91 offen lds
    s_add_u32 m0, s28, 1088
    s_add_u32 s91, s88, 4096
    buffer_load_dwordx4 v225, s[56:59], s91 offen lds
    s_add_u32 m0, s28, 2176
    s_add_u32 s91, s88, 8192
    buffer_load_dwordx4 v225, s[56:59], s91 offen lds
    s_add_u32 m0, s28, 3264
    s_add_u32 s91, s88, 12288
    buffer_load_dwordx4 v225, s[56:59], s91 offen lds
    s_add_u32 m0, s28, 4352
    s_add_u32 s91, s88, 65536
    buffer_load_dwordx4 v225, s[56:59], s91 offen lds
    s_add_u32 m0, s28, 5440
    s_add_u32 s91, s88, 69632
    buffer_load_dwordx4 v225, s[56:59], s91 offen lds
    s_add_u32 m0, s28, 6528
    s_add_u32 s91, s88, 73728
    buffer_load_dwordx4 v225, s[56:59], s91 offen lds
    s_add_u32 m0, s28, 7616
    s_add_u32 s91, s88, 77824
    buffer_load_dwordx4 v225, s[56:59], s91 offen lds
    s_nop 7
    v_fma_f32 v32, v32, s60, -v226
    v_fma_f32 v33, v33, s60, -v226
    v_fma_f32 v34, v34, s60, -v226
    v_fma_f32 v35, v35, s60, -v226
    v_fma_f32 v36, v36, s60, -v226
    v_fma_f32 v37, v37, s60, -v226
    v_fma_f32 v38, v38, s60, -v226
    v_fma_f32 v39, v39, s60, -v226
    v_fma_f32 v40, v40, s60, -v226
    v_fma_f32 v41, v41, s60, -v226
    v_fma_f32 v42, v42, s60, -v226
    v_fma_f32 v43, v43, s60, -v226
    v_fma_f32 v44, v44, s60, -v226
    v_fma_f32 v45, v45, s60, -v226
    v_fma_f32 v46, v46, s60, -v226
    v_fma_f32 v47, v47, s60, -v226
    v_exp_f32 v32, v32
    v_exp_f32 v33, v33
    v_exp_f32 v34, v34
    v_exp_f32 v35, v35
    v_exp_f32 v36, v36
    v_exp_f32 v37, v37
    v_exp_f32 v38, v38
    v_exp_f32 v39, v39
    v_exp_f32 v40, v40
    v_exp_f32 v41, v41
    v_exp_f32 v42, v42
    v_exp_f32 v43, v43
    v_exp_f32 v44, v44
    v_exp_f32 v45, v45
    v_exp_f32 v46, v46
    v_exp_f32 v47, v47
    s_nop 0
    v_cvt_pk_bf16_f32 v20, v32, v33
    v_cvt_pk_bf16_f32 v21, v34, v35
    v_cvt_pk_bf16_f32 v22, v36, v37
    v_cvt_pk_bf16_f32 v23, v38, v39
    v_cvt_pk_bf16_f32 v24, v40, v41
    v_cvt_pk_bf16_f32 v25, v42, v43
    v_cvt_pk_bf16_f32 v26, v44, v45
    v_cvt_pk_bf16_f32 v27, v46, v47
    s_waitcnt vmcnt(0)
    ds_read_b64_tr_b16 v[192:193], v4 offset:8320
    ds_read_b64_tr_b16 v[194:195], v4 offset:8832
    ds_read_b64_tr_b16 v[196:197], v4 offset:8384
    ds_read_b64_tr_b16 v[198:199], v4 offset:8896
    ds_read_b64_tr_b16 v[200:201], v4 offset:8448
    ds_read_b64_tr_b16 v[202:203], v4 offset:8960
    ds_read_b64_tr_b16 v[204:205], v4 offset:8512
    ds_read_b64_tr_b16 v[206:207], v4 offset:9024
    ds_read_b64_tr_b16 v[208:209], v4 offset:12672
    ds_read_b64_tr_b16 v[210:211], v4 offset:13184
    ds_read_b64_tr_b16 v[212:213], v4 offset:12736
    ds_read_b64_tr_b16 v[214:215], v4 offset:13248
    ds_read_b64_tr_b16 v[216:217], v4 offset:12800
    ds_read_b64_tr_b16 v[218:219], v4 offset:13312
    ds_read_b64_tr_b16 v[220:221], v4 offset:12864
    ds_read_b64_tr_b16 v[222:223], v4 offset:13376
    s_waitcnt lgkmcnt(0)
    v_mfma_f32_32x32x16_bf16 v[64:79], v[192:195], v[20:23], v[64:79]
    v_mfma_f32_32x32x16_bf16 v[80:95], v[196:199], v[20:23], v[80:95]
    v_mfma_f32_32x32x16_bf16 v[96:111], v[200:203], v[20:23], v[96:111]
    v_mfma_f32_32x32x16_bf16 v[112:127], v[204:207], v[20:23], v[112:127]
    v_mfma_f32_16x16x32_bf16 v[12:15], v[16:19], v[20:23], v[12:15]
    v_mfma_f32_32x32x16_bf16 v[64:79], v[208:211], v[24:27], v[64:79]
    v_mfma_f32_32x32x16_bf16 v[80:95], v[212:215], v[24:27], v[80:95]
    v_mfma_f32_32x32x16_bf16 v[96:111], v[216:219], v[24:27], v[96:111]
    v_mfma_f32_32x32x16_bf16 v[112:127], v[220:223], v[24:27], v[112:127]
    v_mfma_f32_16x16x32_bf16 v[12:15], v[16:19], v[24:27], v[12:15]
L_fb_next:
    s_add_u32 s88, s88, 0x20000
    s_sub_u32 s89, s89, 32
    s_cmp_gt_i32 s89, 0
    s_cbranch_scc1 L_fb_tile
    s_cmp_eq_u32 s90, 0
    s_cbranch_scc0 L_fb_out
    s_mov_b32 s90, 1
    v_mov_b32 v227, v226
    s_nop 1
    v_permlane32_swap_b32 v227, v226
    v_max_f32 v226, v226, v227
    v_mul_f32 v226, s60, v226
    v_mov_b32 v64, 0
    v_mov_b32 v65, 0
    v_mov_b32 v66, 0
    v_mov_b32 v67, 0
    v_mov_b32 v68, 0
    v_mov_b32 v69, 0
    v_mov_b32 v70, 0
    v_mov_b32 v71, 0
    v_mov_b32 v72, 0
    v_mov_b32 v73, 0
    v_mov_b32 v74, 0
    v_mov_b32 v75, 0
    v_mov_b32 v76, 0
    v_mov_b32 v77, 0
    v_mov_b32 v78, 0
    v_mov_b32 v79, 0
    v_mov_b32 v80, 0
    v_mov_b32 v81, 0
    v_mov_b32 v82, 0
    v_mov_b32 v83, 0
    v_mov_b32 v84, 0
    v_mov_b32 v85, 0
    v_mov_b32 v86, 0
    v_mov_b32 v87, 0
    v_mov_b32 v88, 0
    v_mov_b32 v89, 0
    v_mov_b32 v90, 0
    v_mov_b32 v91, 0
    v_mov_b32 v92, 0
    v_mov_b32 v93, 0
    v_mov_b32 v94, 0
    v_mov_b32 v95, 0
    v_mov_b32 v96, 0
    v_mov_b32 v97, 0
    v_mov_b32 v98, 0
    v_mov_b32 v99, 0
    v_mov_b32 v100, 0
    v_mov_b32 v101, 0
    v_mov_b32 v102, 0
    v_mov_b32 v103, 0
    v_mov_b32 v104, 0
    v_mov_b32 v105, 0
    v_mov_b32 v106, 0
    v_mov_b32 v107, 0
    v_mov_b32 v108, 0
    v_mov_b32 v109, 0
    v_mov_b32 v110, 0
    v_mov_b32 v111, 0
    v_mov_b32 v112, 0
    v_mov_b32 v113, 0
    v_mov_b32 v114, 0
    v_mov_b32 v115, 0
    v_mov_b32 v116, 0
    v_mov_b32 v117, 0
    v_mov_b32 v118, 0
    v_mov_b32 v119, 0
    v_mov_b32 v120, 0
    v_mov_b32 v121, 0
    v_mov_b32 v122, 0
    v_mov_b32 v123, 0
    v_mov_b32 v124, 0
    v_mov_b32 v125, 0
    v_mov_b32 v126, 0
    v_mov_b32 v127, 0
    v_mov_b32 v12, 0
    v_mov_b32 v13, 0
    v_mov_b32 v14, 0
    v_mov_b32 v15, 0
    s_branch L_fb_pass
L_fb_out:
    s_nop 15
    v_rcp_f32 v28, v12
    v_mov_b32 v160, 0
    v_mov_b32 v161, 0
    v_mov_b32 v162, 0
    v_mov_b32 v163, 0
    v_mov_b32 v164, 0
    v_mov_b32 v165, 0
    v_mov_b32 v166, 0
    v_mov_b32 v167, 0
    v_mov_b32 v168, 0
    v_mov_b32 v169, 0
    v_mov_b32 v170, 0
    v_mov_b32 v171, 0
    v_mov_b32 v172, 0
    v_mov_b32 v173, 0
    v_mov_b32 v174, 0
    v_mov_b32 v175, 0
    v_mov_b32 v176, 0
    v_mov_b32 v177, 0
    v_mov_b32 v178, 0
    v_mov_b32 v179, 0
    v_mov_b32 v180, 0
    v_mov_b32 v181, 0
    v_mov_b32 v182, 0
    v_mov_b32 v183, 0
    v_mov_b32 v184, 0
    v_mov_b32 v185, 0
    v_mov_b32 v186, 0
    v_mov_b32 v187, 0
    v_mov_b32 v188, 0
    v_mov_b32 v189, 0
    v_mov_b32 v190, 0
    v_mov_b32 v191, 0
    s_cmp_eq_u32 s21, 0
    s_cbranch_scc1 L_fN
    s_branch L_fS
.section .rodata,"a"
.p2align 6
.amdhsa_kernel standalone__ragged_sequences_packed_sequences__ragged_kernel
  .amdhsa_next_free_vgpr 256
  .amdhsa_next_free_sgpr 102
  .amdhsa_accum_offset 256
  .amdhsa_group_segment_fixed_size 0
  .amdhsa_kernarg_size 56
  .amdhsa_user_sgpr_count 2
  .amdhsa_user_sgpr_kernarg_segment_ptr 1
  .amdhsa_system_sgpr_workgroup_id_x 1
.end_amdhsa_kernel
```
